```python
import torch

def _softmax(x, axis=-1):
    return torch.softmax(x, dim=axis)
def _gelu(x):
    return torch.nn.functional.gelu(x, approximate="tanh")
def _silu(x):
    return torch.nn.functional.silu(x)
def _sigmoid(x):
    return torch.sigmoid(x)
def _layernorm(x, axis=-1, eps=1e-5):
    m = x.mean(dim=axis, keepdim=True)
    v = x.var(dim=axis, keepdim=True, unbiased=False)
    return (x - m) / torch.sqrt(v + eps)
def _scatter_add(tgt, idx, src, axis=0):
    return tgt.clone().index_add_(axis, idx, src)
def _segment_sum(src, seg, n):
    out = torch.zeros((n,) + src.shape[1:], dtype=src.dtype)
    return out.index_add_(0, seg, src)
def _pad(x, pw):
    flat = tuple(v for pair in reversed(pw) for v in pair)
    return torch.nn.functional.pad(x, flat)

kernel_name = 'concat_heads__mha_block_cached__gqa_block_cached__near_ridge'

def setup_inputs():

    _w = (lambda a: (lambda t: t.to(torch.bfloat16) if t.is_floating_point() else t)(torch.as_tensor(a)))
    def _A_setup():
        B, Sq, D = 16, 112, 576
        H, Sk, Dh = 32, 512, 128
        return {
            "x": _w((lambda *s: torch.randn(*s, dtype=torch.bfloat16) * 0.8)(B, Sq, D)),
            "k_cache": _w((lambda *s: torch.randn(*s, dtype=torch.bfloat16) * 0.8)(B, H, Sk, Dh)),
            "v_cache": _w((lambda *s: torch.randn(*s, dtype=torch.bfloat16) * 0.05)(B, H, Sk, Dh)),
            "wq": _w((lambda *s: torch.randn(*s, dtype=torch.bfloat16) * 0.8)(D, H * Dh) * (D ** -0.5)),
            "wo": _w((lambda *s: torch.randn(*s, dtype=torch.bfloat16) * 0.05)(H * Dh, D) * ((H * Dh) ** -0.5)),
        }
    _A_in = _A_setup()

    def _B_setup():
        B, Sq, D = 16, 112, 576
        Hq, Hkv, Sk, Dh = 32, 32, 512, 128
        assert Hq % Hkv == 0, (Hq, Hkv)
        return {
            "x": _w((lambda *s: torch.randn(*s, dtype=torch.bfloat16) * 0.8)(B, Sq, D)),
            "k_cache": _w((lambda *s: torch.randn(*s, dtype=torch.bfloat16) * 0.8)(B, Hkv, Sk, Dh)),
            "v_cache": _w((lambda *s: torch.randn(*s, dtype=torch.bfloat16) * 0.05)(B, Hkv, Sk, Dh)),
            "wq": _w((lambda *s: torch.randn(*s, dtype=torch.bfloat16) * 0.8)(D, Hq * Dh) * (D ** -0.5)),
            "wo": _w((lambda *s: torch.randn(*s, dtype=torch.bfloat16) * 0.05)(Hq * Dh, D) * ((Hq * Dh) ** -0.5)),
        }
    _B_in = _B_setup()

    return {
        "A_x": _A_in["x"],
        "A_k_cache": _A_in["k_cache"],
        "A_v_cache": _A_in["v_cache"],
        "A_wq": _A_in["wq"],
        "A_wo": _A_in["wo"],
        "B_x": _B_in["x"],
        "B_k_cache": _B_in["k_cache"],
        "B_v_cache": _B_in["v_cache"],
        "B_wq": _B_in["wq"],
        "B_wo": _B_in["wo"],
    }

def reference(A_x, A_k_cache, A_v_cache, A_wq, A_wo, B_x, B_k_cache, B_v_cache, B_wq, B_wo):
    def _A_ref(x, k_cache, v_cache, wq, wo):
        B, Sq, D = x.shape
        H, Dh = 32, 128
        q = (lambda x, *d: x.permute(*d))((x @ wq).reshape(B, Sq, H, Dh), 0, 2, 1, 3)
        scores = torch.einsum("bhqd,bhkd->bhqk", q, k_cache) * (Dh ** -0.5)
        p = _softmax(scores, axis=-1)
        o = torch.einsum("bhqk,bhkd->bhqd", p, v_cache)
        return (lambda x, *d: x.permute(*d))(o, 0, 2, 1, 3).reshape(B, Sq, H * Dh) @ wo

    def _B_ref(x, k_cache, v_cache, wq, wo):
        B, Sq, D = x.shape
        Hq, Dh = 32, 128
        Hkv = k_cache.shape[1]
        rep = Hq // Hkv
        q = (lambda x, *d: x.permute(*d))((x @ wq).reshape(B, Sq, Hq, Dh), 0, 2, 1, 3)
        k = (lambda x, n, axis: torch.repeat_interleave(x, n, dim=axis))(k_cache, rep, axis=1)
        v = (lambda x, n, axis: torch.repeat_interleave(x, n, dim=axis))(v_cache, rep, axis=1)
        scores = torch.einsum("bhqd,bhkd->bhqk", q, k) * (Dh ** -0.5)
        p = _softmax(scores, axis=-1)
        o = torch.einsum("bhqk,bhkd->bhqd", p, v)
        return (lambda x, *d: x.permute(*d))(o, 0, 2, 1, 3).reshape(B, Sq, Hq * Dh) @ wo

    a = _A_ref(A_x, A_k_cache, A_v_cache, A_wq, A_wo)
    b = _B_ref(B_x, B_k_cache, B_v_cache, B_wq, B_wo)
    return torch.concatenate([a, b], axis=-1)
```

```asm
; @launch kernel=attn_main_kernel grid=(256,1,1) block=(256,1,1) lds=163840
; @launch kernel=attn_reduce_kernel grid=(1024,1,1) block=(256,1,1) lds=0
.amdgcn_target "amdgcn-amd-amdhsa--gfx950"
.text
.globl attn_main_kernel
.p2align 8
.type attn_main_kernel,@function
attn_main_kernel:
    s_cmp_ge_u32 s2, 256
    s_cbranch_scc1 L_exit
    s_and_b32 s50, s2, 1
    s_mul_i32 s55, s50, 40
    s_add_u32 s4, s0, s55
    s_addc_u32 s5, s1, 0
    s_load_dwordx2 s[72:73], s[4:5], 0
    s_load_dwordx2 s[78:79], s[4:5], 24
    s_load_dwordx2 s[74:75], s[4:5], 8
    s_load_dwordx2 s[76:77], s[4:5], 16
    s_load_dwordx2 s[80:81], s[4:5], 32
    s_load_dwordx2 s[82:83], s[0:1], 96
    s_and_b32 s48, s2, 7
    s_lshr_b32 s49, s2, 3
    s_and_b32 s53, s49, 1
    s_lshr_b32 s51, s48, 1
    s_lshr_b32 s52, s49, 1
    s_lshl_b32 s54, s51, 1
    s_add_u32 s54, s54, s53
    v_lshrrev_b32 v1, 6, v0
    v_and_b32 v0, 63, v0
    v_readfirstlane_b32 s3, v1
    v_lshrrev_b32 v232, 3, v0
    v_and_b32 v233, 7, v0
    v_bfe_u32 v235, v0, 4, 1
    v_lshlrev_b32 v235, 1, v235
    v_xor_b32 v235, v235, v233
    v_lshlrev_b32 v235, 4, v235
    v_lshlrev_b32 v234, 13, v232
    v_add_u32 v9, v234, v235
    v_xor_b32 v10, 64, v9
    v_add_u32 v10, 64512, v10
    v_add_u32 v11, 129024, v9
    v_add_u32 v12, 129024, v10
    v_lshrrev_b32 v237, 4, v0
    v_and_b32 v239, 3, v0
    v_lshrrev_b32 v232, 2, v0
    v_sub_u32 v233, 0, v237
    v_and_b32 v233, 3, v233
    v_xor_b32 v233, v233, v239
    v_lshlrev_b32 v233, 4, v233
    v_mul_u32_u24 v234, 1152, v232
    v_add_u32 v13, v234, v233
    s_mul_i32 s32, s3, 40960
    s_mul_i32 s45, s3, 18432
    s_lshl_b32 s46, s3, 10
    s_lshl_b32 s6, s54, 2
    s_add_u32 s56, s6, s3
    s_mov_b32 s41, 0
    s_waitcnt lgkmcnt(0)
    s_lshl_b32 s6, s56, 8
    s_sub_u32 s7, 4718592, s6
    s_add_u32 s12, s78, s6
    s_addc_u32 s13, s79, 0
    s_and_b32 s13, s13, 0xffff
    s_mov_b32 s14, s7
    s_mov_b32 s15, 0x20000
    s_mul_i32 s6, s52, 129024
    s_add_u32 s8, s72, s6
    s_addc_u32 s9, s73, 0
    s_and_b32 s9, s9, 0xffff
    s_mov_b32 s10, 129024
    s_mov_b32 s11, 0x20000
    s_add_u32 m0, s32, 16384
    s_add_u32 s33, s41, 0
    buffer_load_dwordx4 v9, s[12:15], s33 offen offset:0 lds
    buffer_load_dwordx4 v10, s[12:15], s33 offen offset:1024 lds
    buffer_load_dwordx4 v11, s[12:15], s33 offen offset:2048 lds
    buffer_load_dwordx4 v12, s[12:15], s33 offen offset:3072 lds
    s_add_u32 m0, s46, 32768
    s_add_u32 s33, s45, 0
    buffer_load_dwordx4 v13, s[8:11], s33 offen lds
    s_add_u32 m0, s46, 36864
    s_add_u32 s33, s45, 73728
    buffer_load_dwordx4 v13, s[8:11], s33 offen lds
    s_add_u32 m0, s46, 73728
    s_add_u32 s33, s45, 64
    buffer_load_dwordx4 v13, s[8:11], s33 offen lds
    s_add_u32 m0, s46, 77824
    s_add_u32 s33, s45, 73792
    buffer_load_dwordx4 v13, s[8:11], s33 offen lds
    s_add_u32 m0, s32, 20480
    s_add_u32 s33, s41, 128
    buffer_load_dwordx4 v9, s[12:15], s33 offen offset:0 lds
    buffer_load_dwordx4 v10, s[12:15], s33 offen offset:1024 lds
    buffer_load_dwordx4 v11, s[12:15], s33 offen offset:2048 lds
    buffer_load_dwordx4 v12, s[12:15], s33 offen offset:3072 lds
    s_add_u32 m0, s32, 24576
    s_add_u32 s33, s41, 262144
    buffer_load_dwordx4 v9, s[12:15], s33 offen offset:0 lds
    buffer_load_dwordx4 v10, s[12:15], s33 offen offset:1024 lds
    buffer_load_dwordx4 v11, s[12:15], s33 offen offset:2048 lds
    buffer_load_dwordx4 v12, s[12:15], s33 offen offset:3072 lds
    s_add_u32 m0, s32, 28672
    s_add_u32 s33, s41, 262272
    buffer_load_dwordx4 v9, s[12:15], s33 offen offset:0 lds
    buffer_load_dwordx4 v10, s[12:15], s33 offen offset:1024 lds
    buffer_load_dwordx4 v11, s[12:15], s33 offen offset:2048 lds
    buffer_load_dwordx4 v12, s[12:15], s33 offen offset:3072 lds
    s_add_u32 m0, s46, 114688
    s_add_u32 s33, s45, 128
    buffer_load_dwordx4 v13, s[8:11], s33 offen lds
    s_add_u32 m0, s46, 118784
    s_add_u32 s33, s45, 73856
    buffer_load_dwordx4 v13, s[8:11], s33 offen lds
    s_add_u32 m0, s46, 155648
    s_add_u32 s33, s45, 192
    buffer_load_dwordx4 v13, s[8:11], s33 offen lds
    s_add_u32 m0, s46, 159744
    s_add_u32 s33, s45, 73920
    buffer_load_dwordx4 v13, s[8:11], s33 offen lds
    s_mov_b32 s60, 81920
    s_lshl_b32 s6, s52, 5
    s_add_u32 s6, s6, s56
    s_lshl_b32 s6, s6, 17
    s_add_u32 s16, s74, s6
    s_addc_u32 s17, s75, 0
    s_and_b32 s17, s17, 0xffff
    s_mov_b32 s18, 131072
    s_mov_b32 s19, 0x20000
    s_add_u32 s20, s76, s6
    s_addc_u32 s21, s77, 0
    s_and_b32 s21, s21, 0xffff
    s_mov_b32 s22, 131072
    s_mov_b32 s23, 0x20000
    s_lshl_b32 s6, s51, 11
    s_sub_u32 s7, 4718592, s6
    s_add_u32 s84, s78, s6
    s_addc_u32 s85, s79, 0
    s_and_b32 s85, s85, 0xffff
    s_mov_b32 s86, s7
    s_mov_b32 s87, 0x20000
    s_lshl_b32 s6, s49, 2
    s_add_u32 s6, s6, s3
    s_mul_i32 s57, s6, 72
    v_mov_b32 v233, 0x7fffff00
    v_cmp_gt_u32 vcc, 36, v0
    v_add_u32 v232, s57, v0
    v_lshrrev_b32 v234, 4, v232
    v_lshlrev_b32 v234, 13, v234
    v_and_b32 v232, 15, v232
    v_lshl_add_u32 v232, v232, 7, v234
    v_cndmask_b32 v232, v233, v232, vcc
    buffer_load_dword v23, v232, s[84:87], 0 offen
    v_add_u32 v232, s57, v0
    v_add_u32 v232, 36, v232
    v_lshrrev_b32 v234, 4, v232
    v_lshlrev_b32 v234, 13, v234
    v_and_b32 v232, 15, v232
    v_lshl_add_u32 v232, v232, 7, v234
    v_cndmask_b32 v232, v233, v232, vcc
    buffer_load_dword v23, v232, s[84:87], 0 offen
    v_and_b32 v236, 15, v0
    v_bfe_u32 v238, v0, 2, 2
    s_mov_b32 s38, 0x47800000
    s_mov_b32 s39, 0x3e0293ee
    s_mov_b32 s40, 0xbe0293ee
    v_lshrrev_b32 v232, 1, v238
    v_and_b32 v233, 1, v237
    v_lshl_or_b32 v232, v233, 1, v232
    v_lshlrev_b32 v232, 1, v232
    v_lshrrev_b32 v233, 1, v239
    v_xor_b32 v232, v232, v233
    v_lshlrev_b32 v232, 4, v232
    v_lshl_add_u32 v233, v237, 3, v238
    v_lshl_add_u32 v232, v233, 7, v232
    v_and_b32 v233, 1, v239
    v_lshl_add_u32 v232, v233, 3, v232
    s_add_u32 s6, s32, 16384
    v_add_u32 v232, s6, v232
    v_xor_b32 v15, 0, v232
    v_xor_b32 v16, 32, v232
    v_xor_b32 v17, 64, v232
    v_xor_b32 v18, 96, v232
    v_lshrrev_b32 v232, 2, v236
    v_sub_u32 v232, 0, v232
    v_and_b32 v232, 3, v232
    v_xor_b32 v232, v232, v237
    v_lshlrev_b32 v232, 4, v232
    v_lshl_add_u32 v232, v236, 6, v232
    v_add_u32 v14, 32768, v232
    v_and_b32 v233, 15, v0
    v_lshlrev_b32 v234, 8, v237
    v_add_u32 v235, 0, v237
    v_xor_b32 v235, v235, v233
    v_lshl_add_u32 v1, v235, 4, v234
    v_add_u32 v235, 4, v237
    v_xor_b32 v235, v235, v233
    v_lshl_add_u32 v2, v235, 4, v234
    v_add_u32 v235, 8, v237
    v_xor_b32 v235, v235, v233
    v_lshl_add_u32 v3, v235, 4, v234
    v_add_u32 v235, 12, v237
    v_xor_b32 v235, v235, v233
    v_lshl_add_u32 v4, v235, 4, v234
    v_lshlrev_b32 v235, 1, v237
    v_xor_b32 v235, v235, v233
    v_lshl_add_u32 v5, v235, 4, v234
    v_xor_b32 v6, 128, v5
    v_lshrrev_b32 v232, 1, v237
    v_xor_b32 v232, v232, v236
    v_lshlrev_b32 v232, 4, v232
    v_lshl_add_u32 v232, v236, 8, v232
    v_and_b32 v233, 1, v237
    v_lshl_add_u32 v7, v233, 3, v232
    v_lshl_add_u32 v232, v237, 2, v238
    v_and_b32 v233, 7, v232
    v_lshlrev_b32 v233, 1, v233
    v_lshrrev_b32 v234, 1, v239
    v_xor_b32 v233, v233, v234
    v_lshlrev_b32 v233, 4, v233
    v_lshl_add_u32 v232, v232, 8, v233
    v_and_b32 v233, 1, v239
    v_lshl_add_u32 v8, v233, 3, v232
    v_mov_b32 v252, 0
    v_mov_b32 v253, 0
    v_mov_b32 v254, 0
    v_mov_b32 v255, 0
    v_mov_b32 v24, 0
    v_mov_b32 v25, 0
    v_mov_b32 v26, 0
    v_mov_b32 v27, 0
    v_mov_b32 v28, 0
    v_mov_b32 v29, 0
    v_mov_b32 v30, 0
    s_nop 1
    v_mfma_f32_32x32x16_bf16 a[80:95], v[252:255], v[252:255], 0
    v_mfma_f32_32x32x16_bf16 a[96:111], v[252:255], v[252:255], 0
    v_mfma_f32_32x32x16_bf16 a[112:127], v[252:255], v[252:255], 0
    v_mfma_f32_32x32x16_bf16 a[128:143], v[252:255], v[252:255], 0
    v_mfma_f32_32x32x16_bf16 a[144:159], v[252:255], v[252:255], 0
    v_mfma_f32_32x32x16_bf16 a[160:175], v[252:255], v[252:255], 0
    v_mfma_f32_32x32x16_bf16 a[176:191], v[252:255], v[252:255], 0
    v_mfma_f32_32x32x16_bf16 a[192:207], v[252:255], v[252:255], 0
    v_mfma_f32_32x32x16_bf16 a[208:223], v[252:255], v[252:255], 0
    s_waitcnt vmcnt(18)
    s_barrier
    ds_read_b128 a[0:3], v14 offset:0
    ds_read_b128 a[4:7], v14 offset:1024
    ds_read_b128 a[8:11], v14 offset:2048
    ds_read_b128 a[12:15], v14 offset:3072
    ds_read_b128 a[16:19], v14 offset:4096
    ds_read_b128 a[20:23], v14 offset:5120
    ds_read_b128 a[24:27], v14 offset:6144
    ds_read_b64_tr_b16 a[56:57], v15 offset:0
    ds_read_b64_tr_b16 a[58:59], v15 offset:512
    ds_read_b64_tr_b16 a[60:61], v16 offset:0
    ds_read_b64_tr_b16 a[62:63], v16 offset:512
    s_waitcnt lgkmcnt(0)
    s_mov_b32 s35, 0
    v_mfma_f32_16x16x32_bf16 v[32:35], a[56:59], a[0:3], 0
    v_mfma_f32_16x16x32_bf16 v[36:39], a[56:59], a[4:7], 0
    ds_read_b64_tr_b16 a[64:65], v17 offset:0
    v_mfma_f32_16x16x32_bf16 v[40:43], a[56:59], a[8:11], 0
    ds_read_b64_tr_b16 a[66:67], v17 offset:512
    v_mfma_f32_16x16x32_bf16 v[44:47], a[56:59], a[12:15], 0
    v_mfma_f32_16x16x32_bf16 v[48:51], a[56:59], a[16:19], 0
    v_mfma_f32_16x16x32_bf16 v[52:55], a[56:59], a[20:23], 0
    v_mfma_f32_16x16x32_bf16 v[56:59], a[56:59], a[24:27], 0
    s_waitcnt lgkmcnt(2)
    v_mfma_f32_16x16x32_bf16 v[60:63], a[60:63], a[0:3], 0
    v_mfma_f32_16x16x32_bf16 v[64:67], a[60:63], a[4:7], 0
    ds_read_b64_tr_b16 a[68:69], v18 offset:0
    v_mfma_f32_16x16x32_bf16 v[68:71], a[60:63], a[8:11], 0
    ds_read_b64_tr_b16 a[70:71], v18 offset:512
    v_mfma_f32_16x16x32_bf16 v[72:75], a[60:63], a[12:15], 0
    v_mfma_f32_16x16x32_bf16 v[76:79], a[60:63], a[16:19], 0
    v_mfma_f32_16x16x32_bf16 v[80:83], a[60:63], a[20:23], 0
    v_mfma_f32_16x16x32_bf16 v[84:87], a[60:63], a[24:27], 0
    s_waitcnt lgkmcnt(2)
    v_mfma_f32_16x16x32_bf16 v[88:91], a[64:67], a[0:3], 0
    s_waitcnt vmcnt(14)
    v_mfma_f32_16x16x32_bf16 v[92:95], a[64:67], a[4:7], 0
    ds_read_b64_tr_b16 a[56:57], v15 offset:4096
    v_mfma_f32_16x16x32_bf16 v[96:99], a[64:67], a[8:11], 0
    ds_read_b64_tr_b16 a[58:59], v15 offset:4608
    v_mfma_f32_16x16x32_bf16 v[100:103], a[64:67], a[12:15], 0
    v_mfma_f32_16x16x32_bf16 v[104:107], a[64:67], a[16:19], 0
    v_mfma_f32_16x16x32_bf16 v[108:111], a[64:67], a[20:23], 0
    v_mfma_f32_16x16x32_bf16 v[112:115], a[64:67], a[24:27], 0
    s_waitcnt lgkmcnt(2)
    v_mfma_f32_16x16x32_bf16 v[116:119], a[68:71], a[0:3], 0
    v_mfma_f32_16x16x32_bf16 v[120:123], a[68:71], a[4:7], 0
    ds_read_b64_tr_b16 a[60:61], v16 offset:4096
    v_mfma_f32_16x16x32_bf16 v[124:127], a[68:71], a[8:11], 0
    ds_read_b64_tr_b16 a[62:63], v16 offset:4608
    v_mfma_f32_16x16x32_bf16 v[128:131], a[68:71], a[12:15], 0
    s_add_u32 m0, s32, 16384
    s_add_u32 s33, s41, 524288
    buffer_load_dwordx4 v9, s[12:15], s33 offen offset:0 lds
    v_mfma_f32_16x16x32_bf16 v[132:135], a[68:71], a[16:19], 0
    buffer_load_dwordx4 v10, s[12:15], s33 offen offset:1024 lds
    v_mfma_f32_16x16x32_bf16 v[136:139], a[68:71], a[20:23], 0
    buffer_load_dwordx4 v11, s[12:15], s33 offen offset:2048 lds
    v_mfma_f32_16x16x32_bf16 v[140:143], a[68:71], a[24:27], 0
    s_waitcnt lgkmcnt(2)
    buffer_load_dwordx4 v12, s[12:15], s33 offen offset:3072 lds
    v_mfma_f32_16x16x32_bf16 v[144:147], a[56:59], a[0:3], 0
    v_mfma_f32_16x16x32_bf16 v[148:151], a[56:59], a[4:7], 0
    ds_read_b64_tr_b16 a[64:65], v17 offset:4096
    v_mfma_f32_16x16x32_bf16 v[152:155], a[56:59], a[8:11], 0
    ds_read_b64_tr_b16 a[66:67], v17 offset:4608
    v_mfma_f32_16x16x32_bf16 v[156:159], a[56:59], a[12:15], 0
    ds_read_b128 a[28:31], v14 offset:40960
    v_mfma_f32_16x16x32_bf16 v[160:163], a[56:59], a[16:19], 0
    ds_read_b128 a[32:35], v14 offset:41984
    v_mfma_f32_16x16x32_bf16 v[164:167], a[56:59], a[20:23], 0
    ds_read_b128 a[36:39], v14 offset:43008
    v_mfma_f32_16x16x32_bf16 v[168:171], a[56:59], a[24:27], 0
    s_waitcnt lgkmcnt(5)
    v_mfma_f32_16x16x32_bf16 v[172:175], a[60:63], a[0:3], 0
    v_mfma_f32_16x16x32_bf16 v[176:179], a[60:63], a[4:7], 0
    ds_read_b64_tr_b16 a[68:69], v18 offset:4096
    v_mfma_f32_16x16x32_bf16 v[180:183], a[60:63], a[8:11], 0
    ds_read_b64_tr_b16 a[70:71], v18 offset:4608
    v_mfma_f32_16x16x32_bf16 v[184:187], a[60:63], a[12:15], 0
    ds_read_b128 a[40:43], v14 offset:44032
    v_mfma_f32_16x16x32_bf16 v[188:191], a[60:63], a[16:19], 0
    ds_read_b128 a[44:47], v14 offset:45056
    v_mfma_f32_16x16x32_bf16 v[192:195], a[60:63], a[20:23], 0
    ds_read_b128 a[48:51], v14 offset:46080
    v_mfma_f32_16x16x32_bf16 v[196:199], a[60:63], a[24:27], 0
    s_waitcnt lgkmcnt(8)
    v_mfma_f32_16x16x32_bf16 v[200:203], a[64:67], a[0:3], 0
    s_waitcnt vmcnt(14)
    v_mfma_f32_16x16x32_bf16 v[204:207], a[64:67], a[4:7], 0
    ds_read_b64_tr_b16 a[56:57], v15 offset:8192
    v_mfma_f32_16x16x32_bf16 v[208:211], a[64:67], a[8:11], 0
    ds_read_b64_tr_b16 a[58:59], v15 offset:8704
    v_mfma_f32_16x16x32_bf16 v[212:215], a[64:67], a[12:15], 0
    ds_read_b128 a[52:55], v14 offset:47104
    v_mfma_f32_16x16x32_bf16 v[216:219], a[64:67], a[16:19], 0
    v_mfma_f32_16x16x32_bf16 v[220:223], a[64:67], a[20:23], 0
    v_mfma_f32_16x16x32_bf16 v[224:227], a[64:67], a[24:27], 0
    s_waitcnt lgkmcnt(6)
    v_mfma_f32_16x16x32_bf16 v[228:231], a[68:71], a[0:3], 0
    v_mfma_f32_16x16x32_bf16 v[232:235], a[68:71], a[4:7], 0
    ds_read_b64_tr_b16 a[60:61], v16 offset:8192
    v_mfma_f32_16x16x32_bf16 v[236:239], a[68:71], a[8:11], 0
    ds_read_b64_tr_b16 a[62:63], v16 offset:8704
    v_mfma_f32_16x16x32_bf16 v[240:243], a[68:71], a[12:15], 0
    s_add_u32 m0, s32, 20480
    s_add_u32 s33, s41, 524416
    buffer_load_dwordx4 v9, s[12:15], s33 offen offset:0 lds
    v_mfma_f32_16x16x32_bf16 v[244:247], a[68:71], a[16:19], 0
    buffer_load_dwordx4 v10, s[12:15], s33 offen offset:1024 lds
    v_mfma_f32_16x16x32_bf16 v[248:251], a[68:71], a[20:23], 0
    buffer_load_dwordx4 v11, s[12:15], s33 offen offset:2048 lds
    v_mfma_f32_16x16x32_bf16 v[252:255], a[68:71], a[24:27], 0
    s_waitcnt lgkmcnt(2)
    buffer_load_dwordx4 v12, s[12:15], s33 offen offset:3072 lds
    v_mfma_f32_16x16x32_bf16 v[32:35], a[56:59], a[28:31], v[32:35]
    v_mfma_f32_16x16x32_bf16 v[36:39], a[56:59], a[32:35], v[36:39]
    ds_read_b64_tr_b16 a[64:65], v17 offset:8192
    v_mfma_f32_16x16x32_bf16 v[40:43], a[56:59], a[36:39], v[40:43]
    ds_read_b64_tr_b16 a[66:67], v17 offset:8704
    v_mfma_f32_16x16x32_bf16 v[44:47], a[56:59], a[40:43], v[44:47]
    v_mfma_f32_16x16x32_bf16 v[48:51], a[56:59], a[44:47], v[48:51]
    v_mfma_f32_16x16x32_bf16 v[52:55], a[56:59], a[48:51], v[52:55]
    v_mfma_f32_16x16x32_bf16 v[56:59], a[56:59], a[52:55], v[56:59]
    s_waitcnt lgkmcnt(2)
    v_mfma_f32_16x16x32_bf16 v[60:63], a[60:63], a[28:31], v[60:63]
    v_mfma_f32_16x16x32_bf16 v[64:67], a[60:63], a[32:35], v[64:67]
    ds_read_b64_tr_b16 a[68:69], v18 offset:8192
    v_mfma_f32_16x16x32_bf16 v[68:71], a[60:63], a[36:39], v[68:71]
    ds_read_b64_tr_b16 a[70:71], v18 offset:8704
    v_mfma_f32_16x16x32_bf16 v[72:75], a[60:63], a[40:43], v[72:75]
    v_mfma_f32_16x16x32_bf16 v[76:79], a[60:63], a[44:47], v[76:79]
    v_mfma_f32_16x16x32_bf16 v[80:83], a[60:63], a[48:51], v[80:83]
    v_mfma_f32_16x16x32_bf16 v[84:87], a[60:63], a[52:55], v[84:87]
    s_waitcnt lgkmcnt(2)
    v_mfma_f32_16x16x32_bf16 v[88:91], a[64:67], a[28:31], v[88:91]
    s_waitcnt vmcnt(14)
    v_mfma_f32_16x16x32_bf16 v[92:95], a[64:67], a[32:35], v[92:95]
    ds_read_b64_tr_b16 a[56:57], v15 offset:12288
    v_mfma_f32_16x16x32_bf16 v[96:99], a[64:67], a[36:39], v[96:99]
    ds_read_b64_tr_b16 a[58:59], v15 offset:12800
    v_mfma_f32_16x16x32_bf16 v[100:103], a[64:67], a[40:43], v[100:103]
    v_mfma_f32_16x16x32_bf16 v[104:107], a[64:67], a[44:47], v[104:107]
    v_mfma_f32_16x16x32_bf16 v[108:111], a[64:67], a[48:51], v[108:111]
    v_mfma_f32_16x16x32_bf16 v[112:115], a[64:67], a[52:55], v[112:115]
    s_waitcnt lgkmcnt(2)
    v_mfma_f32_16x16x32_bf16 v[116:119], a[68:71], a[28:31], v[116:119]
    v_mfma_f32_16x16x32_bf16 v[120:123], a[68:71], a[32:35], v[120:123]
    ds_read_b64_tr_b16 a[60:61], v16 offset:12288
    v_mfma_f32_16x16x32_bf16 v[124:127], a[68:71], a[36:39], v[124:127]
    ds_read_b64_tr_b16 a[62:63], v16 offset:12800
    v_mfma_f32_16x16x32_bf16 v[128:131], a[68:71], a[40:43], v[128:131]
    s_add_u32 m0, s32, 24576
    s_add_u32 s33, s41, 786432
    buffer_load_dwordx4 v9, s[12:15], s33 offen offset:0 lds
    v_mfma_f32_16x16x32_bf16 v[132:135], a[68:71], a[44:47], v[132:135]
    buffer_load_dwordx4 v10, s[12:15], s33 offen offset:1024 lds
    v_mfma_f32_16x16x32_bf16 v[136:139], a[68:71], a[48:51], v[136:139]
    buffer_load_dwordx4 v11, s[12:15], s33 offen offset:2048 lds
    v_mfma_f32_16x16x32_bf16 v[140:143], a[68:71], a[52:55], v[140:143]
    s_waitcnt lgkmcnt(2)
    buffer_load_dwordx4 v12, s[12:15], s33 offen offset:3072 lds
    v_mfma_f32_16x16x32_bf16 v[144:147], a[56:59], a[28:31], v[144:147]
    v_mfma_f32_16x16x32_bf16 v[148:151], a[56:59], a[32:35], v[148:151]
    ds_read_b64_tr_b16 a[64:65], v17 offset:12288
    v_mfma_f32_16x16x32_bf16 v[152:155], a[56:59], a[36:39], v[152:155]
    ds_read_b64_tr_b16 a[66:67], v17 offset:12800
    v_mfma_f32_16x16x32_bf16 v[156:159], a[56:59], a[40:43], v[156:159]
    s_waitcnt vmcnt(14)
    s_barrier
    v_add_u32 v14, s60, v14
    v_mfma_f32_16x16x32_bf16 v[160:163], a[56:59], a[44:47], v[160:163]
    v_mfma_f32_16x16x32_bf16 v[164:167], a[56:59], a[48:51], v[164:167]
    s_add_u32 m0, s46, 32768
    s_add_u32 s33, s45, 256
    buffer_load_dwordx4 v13, s[8:11], s33 offen lds
    v_mfma_f32_16x16x32_bf16 v[168:171], a[56:59], a[52:55], v[168:171]
    s_waitcnt lgkmcnt(2)
    s_add_u32 m0, s46, 77824
    s_add_u32 s33, s45, 74048
    buffer_load_dwordx4 v13, s[8:11], s33 offen lds
    v_mfma_f32_16x16x32_bf16 v[172:175], a[60:63], a[28:31], v[172:175]
    v_mfma_f32_16x16x32_bf16 v[176:179], a[60:63], a[32:35], v[176:179]
    ds_read_b64_tr_b16 a[68:69], v18 offset:12288
    v_mfma_f32_16x16x32_bf16 v[180:183], a[60:63], a[36:39], v[180:183]
    ds_read_b64_tr_b16 a[70:71], v18 offset:12800
    v_mfma_f32_16x16x32_bf16 v[184:187], a[60:63], a[40:43], v[184:187]
    ds_read_b128 a[0:3], v14 offset:0
    v_mfma_f32_16x16x32_bf16 v[188:191], a[60:63], a[44:47], v[188:191]
    ds_read_b128 a[4:7], v14 offset:1024
    v_mfma_f32_16x16x32_bf16 v[192:195], a[60:63], a[48:51], v[192:195]
    s_add_u32 m0, s46, 36864
    s_add_u32 s33, s45, 73984
    buffer_load_dwordx4 v13, s[8:11], s33 offen lds
    ds_read_b128 a[8:11], v14 offset:2048
    v_mfma_f32_16x16x32_bf16 v[196:199], a[60:63], a[52:55], v[196:199]
    s_waitcnt lgkmcnt(5)
    v_mfma_f32_16x16x32_bf16 v[200:203], a[64:67], a[28:31], v[200:203]
    s_waitcnt vmcnt(11)
    v_mfma_f32_16x16x32_bf16 v[204:207], a[64:67], a[32:35], v[204:207]
    ds_read_b64_tr_b16 a[56:57], v15 offset:0
    v_mfma_f32_16x16x32_bf16 v[208:211], a[64:67], a[36:39], v[208:211]
    ds_read_b64_tr_b16 a[58:59], v15 offset:512
    v_mfma_f32_16x16x32_bf16 v[212:215], a[64:67], a[40:43], v[212:215]
    ds_read_b128 a[12:15], v14 offset:3072
    v_mfma_f32_16x16x32_bf16 v[216:219], a[64:67], a[44:47], v[216:219]
    ds_read_b128 a[16:19], v14 offset:4096
    v_mfma_f32_16x16x32_bf16 v[220:223], a[64:67], a[48:51], v[220:223]
    s_add_u32 m0, s46, 73728
    s_add_u32 s33, s45, 320
    buffer_load_dwordx4 v13, s[8:11], s33 offen lds
    ds_read_b128 a[20:23], v14 offset:5120
    v_mfma_f32_16x16x32_bf16 v[224:227], a[64:67], a[52:55], v[224:227]
    s_waitcnt lgkmcnt(8)
    v_mfma_f32_16x16x32_bf16 v[228:231], a[68:71], a[28:31], v[228:231]
    v_mfma_f32_16x16x32_bf16 v[232:235], a[68:71], a[32:35], v[232:235]
    ds_read_b64_tr_b16 a[60:61], v16 offset:0
    v_mfma_f32_16x16x32_bf16 v[236:239], a[68:71], a[36:39], v[236:239]
    ds_read_b64_tr_b16 a[62:63], v16 offset:512
    v_mfma_f32_16x16x32_bf16 v[240:243], a[68:71], a[40:43], v[240:243]
    ds_read_b128 a[24:27], v14 offset:6144
    s_add_u32 m0, s32, 28672
    s_add_u32 s33, s41, 786560
    buffer_load_dwordx4 v9, s[12:15], s33 offen offset:0 lds
    v_mfma_f32_16x16x32_bf16 v[244:247], a[68:71], a[44:47], v[244:247]
    buffer_load_dwordx4 v10, s[12:15], s33 offen offset:1024 lds
    v_mfma_f32_16x16x32_bf16 v[248:251], a[68:71], a[48:51], v[248:251]
    buffer_load_dwordx4 v11, s[12:15], s33 offen offset:2048 lds
    v_mfma_f32_16x16x32_bf16 v[252:255], a[68:71], a[52:55], v[252:255]
    s_waitcnt lgkmcnt(0)
    buffer_load_dwordx4 v12, s[12:15], s33 offen offset:3072 lds
    s_add_u32 s41, s41, 524288
    s_add_u32 s45, s45, 128
    s_add_u32 s46, s46, s60
    s_sub_u32 s60, 0, s60
L_Q:
    v_mfma_f32_16x16x32_bf16 v[32:35], a[56:59], a[0:3], v[32:35]
    v_mfma_f32_16x16x32_bf16 v[36:39], a[56:59], a[4:7], v[36:39]
    ds_read_b64_tr_b16 a[64:65], v17 offset:0
    v_mfma_f32_16x16x32_bf16 v[40:43], a[56:59], a[8:11], v[40:43]
    ds_read_b64_tr_b16 a[66:67], v17 offset:512
    v_mfma_f32_16x16x32_bf16 v[44:47], a[56:59], a[12:15], v[44:47]
    v_mfma_f32_16x16x32_bf16 v[48:51], a[56:59], a[16:19], v[48:51]
    v_mfma_f32_16x16x32_bf16 v[52:55], a[56:59], a[20:23], v[52:55]
    v_mfma_f32_16x16x32_bf16 v[56:59], a[56:59], a[24:27], v[56:59]
    s_waitcnt lgkmcnt(2)
    v_mfma_f32_16x16x32_bf16 v[60:63], a[60:63], a[0:3], v[60:63]
    v_mfma_f32_16x16x32_bf16 v[64:67], a[60:63], a[4:7], v[64:67]
    ds_read_b64_tr_b16 a[68:69], v18 offset:0
    v_mfma_f32_16x16x32_bf16 v[68:71], a[60:63], a[8:11], v[68:71]
    ds_read_b64_tr_b16 a[70:71], v18 offset:512
    v_mfma_f32_16x16x32_bf16 v[72:75], a[60:63], a[12:15], v[72:75]
    v_mfma_f32_16x16x32_bf16 v[76:79], a[60:63], a[16:19], v[76:79]
    v_mfma_f32_16x16x32_bf16 v[80:83], a[60:63], a[20:23], v[80:83]
    v_mfma_f32_16x16x32_bf16 v[84:87], a[60:63], a[24:27], v[84:87]
    s_waitcnt lgkmcnt(2)
    v_mfma_f32_16x16x32_bf16 v[88:91], a[64:67], a[0:3], v[88:91]
    s_waitcnt vmcnt(12)
    v_mfma_f32_16x16x32_bf16 v[92:95], a[64:67], a[4:7], v[92:95]
    ds_read_b64_tr_b16 a[56:57], v15 offset:4096
    v_mfma_f32_16x16x32_bf16 v[96:99], a[64:67], a[8:11], v[96:99]
    ds_read_b64_tr_b16 a[58:59], v15 offset:4608
    v_mfma_f32_16x16x32_bf16 v[100:103], a[64:67], a[12:15], v[100:103]
    v_mfma_f32_16x16x32_bf16 v[104:107], a[64:67], a[16:19], v[104:107]
    v_mfma_f32_16x16x32_bf16 v[108:111], a[64:67], a[20:23], v[108:111]
    v_mfma_f32_16x16x32_bf16 v[112:115], a[64:67], a[24:27], v[112:115]
    s_waitcnt lgkmcnt(2)
    v_mfma_f32_16x16x32_bf16 v[116:119], a[68:71], a[0:3], v[116:119]
    v_mfma_f32_16x16x32_bf16 v[120:123], a[68:71], a[4:7], v[120:123]
    ds_read_b64_tr_b16 a[60:61], v16 offset:4096
    v_mfma_f32_16x16x32_bf16 v[124:127], a[68:71], a[8:11], v[124:127]
    ds_read_b64_tr_b16 a[62:63], v16 offset:4608
    v_mfma_f32_16x16x32_bf16 v[128:131], a[68:71], a[12:15], v[128:131]
    s_add_u32 m0, s32, 16384
    s_add_u32 s33, s41, 524288
    buffer_load_dwordx4 v9, s[12:15], s33 offen offset:0 lds
    v_mfma_f32_16x16x32_bf16 v[132:135], a[68:71], a[16:19], v[132:135]
    buffer_load_dwordx4 v10, s[12:15], s33 offen offset:1024 lds
    v_mfma_f32_16x16x32_bf16 v[136:139], a[68:71], a[20:23], v[136:139]
    buffer_load_dwordx4 v11, s[12:15], s33 offen offset:2048 lds
    v_mfma_f32_16x16x32_bf16 v[140:143], a[68:71], a[24:27], v[140:143]
    s_waitcnt lgkmcnt(2)
    buffer_load_dwordx4 v12, s[12:15], s33 offen offset:3072 lds
    v_mfma_f32_16x16x32_bf16 v[144:147], a[56:59], a[0:3], v[144:147]
    v_mfma_f32_16x16x32_bf16 v[148:151], a[56:59], a[4:7], v[148:151]
    ds_read_b64_tr_b16 a[64:65], v17 offset:4096
    v_mfma_f32_16x16x32_bf16 v[152:155], a[56:59], a[8:11], v[152:155]
    ds_read_b64_tr_b16 a[66:67], v17 offset:4608
    v_mfma_f32_16x16x32_bf16 v[156:159], a[56:59], a[12:15], v[156:159]
    ds_read_b128 a[28:31], v14 offset:40960
    v_mfma_f32_16x16x32_bf16 v[160:163], a[56:59], a[16:19], v[160:163]
    ds_read_b128 a[32:35], v14 offset:41984
    v_mfma_f32_16x16x32_bf16 v[164:167], a[56:59], a[20:23], v[164:167]
    ds_read_b128 a[36:39], v14 offset:43008
    v_mfma_f32_16x16x32_bf16 v[168:171], a[56:59], a[24:27], v[168:171]
    s_waitcnt lgkmcnt(5)
    v_mfma_f32_16x16x32_bf16 v[172:175], a[60:63], a[0:3], v[172:175]
    v_mfma_f32_16x16x32_bf16 v[176:179], a[60:63], a[4:7], v[176:179]
    ds_read_b64_tr_b16 a[68:69], v18 offset:4096
    v_mfma_f32_16x16x32_bf16 v[180:183], a[60:63], a[8:11], v[180:183]
    ds_read_b64_tr_b16 a[70:71], v18 offset:4608
    v_mfma_f32_16x16x32_bf16 v[184:187], a[60:63], a[12:15], v[184:187]
    ds_read_b128 a[40:43], v14 offset:44032
    v_mfma_f32_16x16x32_bf16 v[188:191], a[60:63], a[16:19], v[188:191]
    ds_read_b128 a[44:47], v14 offset:45056
    v_mfma_f32_16x16x32_bf16 v[192:195], a[60:63], a[20:23], v[192:195]
    ds_read_b128 a[48:51], v14 offset:46080
    v_mfma_f32_16x16x32_bf16 v[196:199], a[60:63], a[24:27], v[196:199]
    s_waitcnt lgkmcnt(8)
    v_mfma_f32_16x16x32_bf16 v[200:203], a[64:67], a[0:3], v[200:203]
    s_waitcnt vmcnt(12)
    v_mfma_f32_16x16x32_bf16 v[204:207], a[64:67], a[4:7], v[204:207]
    ds_read_b64_tr_b16 a[56:57], v15 offset:8192
    v_mfma_f32_16x16x32_bf16 v[208:211], a[64:67], a[8:11], v[208:211]
    ds_read_b64_tr_b16 a[58:59], v15 offset:8704
    v_mfma_f32_16x16x32_bf16 v[212:215], a[64:67], a[12:15], v[212:215]
    ds_read_b128 a[52:55], v14 offset:47104
    v_mfma_f32_16x16x32_bf16 v[216:219], a[64:67], a[16:19], v[216:219]
    v_mfma_f32_16x16x32_bf16 v[220:223], a[64:67], a[20:23], v[220:223]
    v_mfma_f32_16x16x32_bf16 v[224:227], a[64:67], a[24:27], v[224:227]
    s_waitcnt lgkmcnt(6)
    v_mfma_f32_16x16x32_bf16 v[228:231], a[68:71], a[0:3], v[228:231]
    v_mfma_f32_16x16x32_bf16 v[232:235], a[68:71], a[4:7], v[232:235]
    ds_read_b64_tr_b16 a[60:61], v16 offset:8192
    v_mfma_f32_16x16x32_bf16 v[236:239], a[68:71], a[8:11], v[236:239]
    ds_read_b64_tr_b16 a[62:63], v16 offset:8704
    v_mfma_f32_16x16x32_bf16 v[240:243], a[68:71], a[12:15], v[240:243]
    s_add_u32 m0, s32, 20480
    s_add_u32 s33, s41, 524416
    buffer_load_dwordx4 v9, s[12:15], s33 offen offset:0 lds
    v_mfma_f32_16x16x32_bf16 v[244:247], a[68:71], a[16:19], v[244:247]
    buffer_load_dwordx4 v10, s[12:15], s33 offen offset:1024 lds
    v_mfma_f32_16x16x32_bf16 v[248:251], a[68:71], a[20:23], v[248:251]
    buffer_load_dwordx4 v11, s[12:15], s33 offen offset:2048 lds
    v_mfma_f32_16x16x32_bf16 v[252:255], a[68:71], a[24:27], v[252:255]
    s_waitcnt lgkmcnt(2)
    buffer_load_dwordx4 v12, s[12:15], s33 offen offset:3072 lds
    v_mfma_f32_16x16x32_bf16 v[32:35], a[56:59], a[28:31], v[32:35]
    v_mfma_f32_16x16x32_bf16 v[36:39], a[56:59], a[32:35], v[36:39]
    ds_read_b64_tr_b16 a[64:65], v17 offset:8192
    v_mfma_f32_16x16x32_bf16 v[40:43], a[56:59], a[36:39], v[40:43]
    ds_read_b64_tr_b16 a[66:67], v17 offset:8704
    v_mfma_f32_16x16x32_bf16 v[44:47], a[56:59], a[40:43], v[44:47]
    v_mfma_f32_16x16x32_bf16 v[48:51], a[56:59], a[44:47], v[48:51]
    v_mfma_f32_16x16x32_bf16 v[52:55], a[56:59], a[48:51], v[52:55]
    v_mfma_f32_16x16x32_bf16 v[56:59], a[56:59], a[52:55], v[56:59]
    s_waitcnt lgkmcnt(2)
    v_mfma_f32_16x16x32_bf16 v[60:63], a[60:63], a[28:31], v[60:63]
    v_mfma_f32_16x16x32_bf16 v[64:67], a[60:63], a[32:35], v[64:67]
    ds_read_b64_tr_b16 a[68:69], v18 offset:8192
    v_mfma_f32_16x16x32_bf16 v[68:71], a[60:63], a[36:39], v[68:71]
    ds_read_b64_tr_b16 a[70:71], v18 offset:8704
    v_mfma_f32_16x16x32_bf16 v[72:75], a[60:63], a[40:43], v[72:75]
    v_mfma_f32_16x16x32_bf16 v[76:79], a[60:63], a[44:47], v[76:79]
    v_mfma_f32_16x16x32_bf16 v[80:83], a[60:63], a[48:51], v[80:83]
    v_mfma_f32_16x16x32_bf16 v[84:87], a[60:63], a[52:55], v[84:87]
    s_waitcnt lgkmcnt(2)
    v_mfma_f32_16x16x32_bf16 v[88:91], a[64:67], a[28:31], v[88:91]
    s_waitcnt vmcnt(8)
    v_mfma_f32_16x16x32_bf16 v[92:95], a[64:67], a[32:35], v[92:95]
    ds_read_b64_tr_b16 a[56:57], v15 offset:12288
    v_mfma_f32_16x16x32_bf16 v[96:99], a[64:67], a[36:39], v[96:99]
    ds_read_b64_tr_b16 a[58:59], v15 offset:12800
    v_mfma_f32_16x16x32_bf16 v[100:103], a[64:67], a[40:43], v[100:103]
    v_mfma_f32_16x16x32_bf16 v[104:107], a[64:67], a[44:47], v[104:107]
    v_mfma_f32_16x16x32_bf16 v[108:111], a[64:67], a[48:51], v[108:111]
    v_mfma_f32_16x16x32_bf16 v[112:115], a[64:67], a[52:55], v[112:115]
    s_waitcnt lgkmcnt(2)
    v_mfma_f32_16x16x32_bf16 v[116:119], a[68:71], a[28:31], v[116:119]
    v_mfma_f32_16x16x32_bf16 v[120:123], a[68:71], a[32:35], v[120:123]
    ds_read_b64_tr_b16 a[60:61], v16 offset:12288
    v_mfma_f32_16x16x32_bf16 v[124:127], a[68:71], a[36:39], v[124:127]
    ds_read_b64_tr_b16 a[62:63], v16 offset:12800
    v_mfma_f32_16x16x32_bf16 v[128:131], a[68:71], a[40:43], v[128:131]
    s_add_u32 m0, s32, 24576
    s_add_u32 s33, s41, 786432
    buffer_load_dwordx4 v9, s[12:15], s33 offen offset:0 lds
    v_mfma_f32_16x16x32_bf16 v[132:135], a[68:71], a[44:47], v[132:135]
    buffer_load_dwordx4 v10, s[12:15], s33 offen offset:1024 lds
    v_mfma_f32_16x16x32_bf16 v[136:139], a[68:71], a[48:51], v[136:139]
    buffer_load_dwordx4 v11, s[12:15], s33 offen offset:2048 lds
    v_mfma_f32_16x16x32_bf16 v[140:143], a[68:71], a[52:55], v[140:143]
    s_waitcnt lgkmcnt(2)
    buffer_load_dwordx4 v12, s[12:15], s33 offen offset:3072 lds
    v_mfma_f32_16x16x32_bf16 v[144:147], a[56:59], a[28:31], v[144:147]
    v_mfma_f32_16x16x32_bf16 v[148:151], a[56:59], a[32:35], v[148:151]
    ds_read_b64_tr_b16 a[64:65], v17 offset:12288
    v_mfma_f32_16x16x32_bf16 v[152:155], a[56:59], a[36:39], v[152:155]
    ds_read_b64_tr_b16 a[66:67], v17 offset:12800
    v_mfma_f32_16x16x32_bf16 v[156:159], a[56:59], a[40:43], v[156:159]
    s_barrier
    v_add_u32 v14, s60, v14
    v_mfma_f32_16x16x32_bf16 v[160:163], a[56:59], a[44:47], v[160:163]
    v_mfma_f32_16x16x32_bf16 v[164:167], a[56:59], a[48:51], v[164:167]
    s_add_u32 m0, s46, 32768
    s_add_u32 s33, s45, 256
    buffer_load_dwordx4 v13, s[8:11], s33 offen lds
    v_mfma_f32_16x16x32_bf16 v[168:171], a[56:59], a[52:55], v[168:171]
    s_waitcnt lgkmcnt(2)
    s_add_u32 m0, s46, 77824
    s_add_u32 s33, s45, 74048
    buffer_load_dwordx4 v13, s[8:11], s33 offen lds
    v_mfma_f32_16x16x32_bf16 v[172:175], a[60:63], a[28:31], v[172:175]
    v_mfma_f32_16x16x32_bf16 v[176:179], a[60:63], a[32:35], v[176:179]
    ds_read_b64_tr_b16 a[68:69], v18 offset:12288
    v_mfma_f32_16x16x32_bf16 v[180:183], a[60:63], a[36:39], v[180:183]
    ds_read_b64_tr_b16 a[70:71], v18 offset:12800
    v_mfma_f32_16x16x32_bf16 v[184:187], a[60:63], a[40:43], v[184:187]
    ds_read_b128 a[0:3], v14 offset:0
    v_mfma_f32_16x16x32_bf16 v[188:191], a[60:63], a[44:47], v[188:191]
    ds_read_b128 a[4:7], v14 offset:1024
    v_mfma_f32_16x16x32_bf16 v[192:195], a[60:63], a[48:51], v[192:195]
    s_add_u32 m0, s46, 36864
    s_add_u32 s33, s45, 73984
    buffer_load_dwordx4 v13, s[8:11], s33 offen lds
    ds_read_b128 a[8:11], v14 offset:2048
    v_mfma_f32_16x16x32_bf16 v[196:199], a[60:63], a[52:55], v[196:199]
    s_waitcnt lgkmcnt(5)
    v_mfma_f32_16x16x32_bf16 v[200:203], a[64:67], a[28:31], v[200:203]
    s_waitcnt vmcnt(11)
    v_mfma_f32_16x16x32_bf16 v[204:207], a[64:67], a[32:35], v[204:207]
    ds_read_b64_tr_b16 a[56:57], v15 offset:0
    v_mfma_f32_16x16x32_bf16 v[208:211], a[64:67], a[36:39], v[208:211]
    ds_read_b64_tr_b16 a[58:59], v15 offset:512
    v_mfma_f32_16x16x32_bf16 v[212:215], a[64:67], a[40:43], v[212:215]
    ds_read_b128 a[12:15], v14 offset:3072
    v_mfma_f32_16x16x32_bf16 v[216:219], a[64:67], a[44:47], v[216:219]
    ds_read_b128 a[16:19], v14 offset:4096
    v_mfma_f32_16x16x32_bf16 v[220:223], a[64:67], a[48:51], v[220:223]
    s_add_u32 m0, s46, 73728
    s_add_u32 s33, s45, 320
    buffer_load_dwordx4 v13, s[8:11], s33 offen lds
    ds_read_b128 a[20:23], v14 offset:5120
    v_mfma_f32_16x16x32_bf16 v[224:227], a[64:67], a[52:55], v[224:227]
    s_waitcnt lgkmcnt(8)
    v_mfma_f32_16x16x32_bf16 v[228:231], a[68:71], a[28:31], v[228:231]
    v_mfma_f32_16x16x32_bf16 v[232:235], a[68:71], a[32:35], v[232:235]
    ds_read_b64_tr_b16 a[60:61], v16 offset:0
    v_mfma_f32_16x16x32_bf16 v[236:239], a[68:71], a[36:39], v[236:239]
    ds_read_b64_tr_b16 a[62:63], v16 offset:512
    v_mfma_f32_16x16x32_bf16 v[240:243], a[68:71], a[40:43], v[240:243]
    ds_read_b128 a[24:27], v14 offset:6144
    s_add_u32 m0, s32, 28672
    s_add_u32 s33, s41, 786560
    buffer_load_dwordx4 v9, s[12:15], s33 offen offset:0 lds
    v_mfma_f32_16x16x32_bf16 v[244:247], a[68:71], a[44:47], v[244:247]
    buffer_load_dwordx4 v10, s[12:15], s33 offen offset:1024 lds
    v_mfma_f32_16x16x32_bf16 v[248:251], a[68:71], a[48:51], v[248:251]
    buffer_load_dwordx4 v11, s[12:15], s33 offen offset:2048 lds
    v_mfma_f32_16x16x32_bf16 v[252:255], a[68:71], a[52:55], v[252:255]
    s_waitcnt lgkmcnt(0)
    buffer_load_dwordx4 v12, s[12:15], s33 offen offset:3072 lds
    s_add_u32 s41, s41, 524288
    s_add_u32 s45, s45, 128
    s_add_u32 s46, s46, s60
    s_sub_u32 s60, 0, s60
    s_add_u32 s35, s35, 1
    s_cmp_lt_u32 s35, 7
    s_cbranch_scc1 L_Q
    v_mfma_f32_16x16x32_bf16 v[32:35], a[56:59], a[0:3], v[32:35]
    v_mfma_f32_16x16x32_bf16 v[36:39], a[56:59], a[4:7], v[36:39]
    ds_read_b64_tr_b16 a[64:65], v17 offset:0
    v_mfma_f32_16x16x32_bf16 v[40:43], a[56:59], a[8:11], v[40:43]
    ds_read_b64_tr_b16 a[66:67], v17 offset:512
    v_mfma_f32_16x16x32_bf16 v[44:47], a[56:59], a[12:15], v[44:47]
    v_mfma_f32_16x16x32_bf16 v[48:51], a[56:59], a[16:19], v[48:51]
    v_mfma_f32_16x16x32_bf16 v[52:55], a[56:59], a[20:23], v[52:55]
    v_mfma_f32_16x16x32_bf16 v[56:59], a[56:59], a[24:27], v[56:59]
    s_waitcnt lgkmcnt(2)
    v_mfma_f32_16x16x32_bf16 v[60:63], a[60:63], a[0:3], v[60:63]
    v_mfma_f32_16x16x32_bf16 v[64:67], a[60:63], a[4:7], v[64:67]
    ds_read_b64_tr_b16 a[68:69], v18 offset:0
    v_mfma_f32_16x16x32_bf16 v[68:71], a[60:63], a[8:11], v[68:71]
    ds_read_b64_tr_b16 a[70:71], v18 offset:512
    v_mfma_f32_16x16x32_bf16 v[72:75], a[60:63], a[12:15], v[72:75]
    v_mfma_f32_16x16x32_bf16 v[76:79], a[60:63], a[16:19], v[76:79]
    v_mfma_f32_16x16x32_bf16 v[80:83], a[60:63], a[20:23], v[80:83]
    v_mfma_f32_16x16x32_bf16 v[84:87], a[60:63], a[24:27], v[84:87]
    s_waitcnt lgkmcnt(2)
    v_mfma_f32_16x16x32_bf16 v[88:91], a[64:67], a[0:3], v[88:91]
    s_waitcnt vmcnt(12)
    v_mfma_f32_16x16x32_bf16 v[92:95], a[64:67], a[4:7], v[92:95]
    ds_read_b64_tr_b16 a[56:57], v15 offset:4096
    v_mfma_f32_16x16x32_bf16 v[96:99], a[64:67], a[8:11], v[96:99]
    ds_read_b64_tr_b16 a[58:59], v15 offset:4608
    v_mfma_f32_16x16x32_bf16 v[100:103], a[64:67], a[12:15], v[100:103]
    v_mfma_f32_16x16x32_bf16 v[104:107], a[64:67], a[16:19], v[104:107]
    v_mfma_f32_16x16x32_bf16 v[108:111], a[64:67], a[20:23], v[108:111]
    v_mfma_f32_16x16x32_bf16 v[112:115], a[64:67], a[24:27], v[112:115]
    s_waitcnt lgkmcnt(2)
    v_mfma_f32_16x16x32_bf16 v[116:119], a[68:71], a[0:3], v[116:119]
    v_mfma_f32_16x16x32_bf16 v[120:123], a[68:71], a[4:7], v[120:123]
    ds_read_b64_tr_b16 a[60:61], v16 offset:4096
    v_mfma_f32_16x16x32_bf16 v[124:127], a[68:71], a[8:11], v[124:127]
    ds_read_b64_tr_b16 a[62:63], v16 offset:4608
    v_mfma_f32_16x16x32_bf16 v[128:131], a[68:71], a[12:15], v[128:131]
    v_mfma_f32_16x16x32_bf16 v[132:135], a[68:71], a[16:19], v[132:135]
    v_mfma_f32_16x16x32_bf16 v[136:139], a[68:71], a[20:23], v[136:139]
    v_mfma_f32_16x16x32_bf16 v[140:143], a[68:71], a[24:27], v[140:143]
    s_waitcnt lgkmcnt(2)
    v_mfma_f32_16x16x32_bf16 v[144:147], a[56:59], a[0:3], v[144:147]
    v_mfma_f32_16x16x32_bf16 v[148:151], a[56:59], a[4:7], v[148:151]
    ds_read_b64_tr_b16 a[64:65], v17 offset:4096
    v_mfma_f32_16x16x32_bf16 v[152:155], a[56:59], a[8:11], v[152:155]
    ds_read_b64_tr_b16 a[66:67], v17 offset:4608
    v_mfma_f32_16x16x32_bf16 v[156:159], a[56:59], a[12:15], v[156:159]
    ds_read_b128 a[28:31], v14 offset:40960
    v_mfma_f32_16x16x32_bf16 v[160:163], a[56:59], a[16:19], v[160:163]
    ds_read_b128 a[32:35], v14 offset:41984
    v_mfma_f32_16x16x32_bf16 v[164:167], a[56:59], a[20:23], v[164:167]
    ds_read_b128 a[36:39], v14 offset:43008
    v_mfma_f32_16x16x32_bf16 v[168:171], a[56:59], a[24:27], v[168:171]
    s_waitcnt lgkmcnt(5)
    v_mfma_f32_16x16x32_bf16 v[172:175], a[60:63], a[0:3], v[172:175]
    v_mfma_f32_16x16x32_bf16 v[176:179], a[60:63], a[4:7], v[176:179]
    ds_read_b64_tr_b16 a[68:69], v18 offset:4096
    v_mfma_f32_16x16x32_bf16 v[180:183], a[60:63], a[8:11], v[180:183]
    ds_read_b64_tr_b16 a[70:71], v18 offset:4608
    v_mfma_f32_16x16x32_bf16 v[184:187], a[60:63], a[12:15], v[184:187]
    ds_read_b128 a[40:43], v14 offset:44032
    v_mfma_f32_16x16x32_bf16 v[188:191], a[60:63], a[16:19], v[188:191]
    ds_read_b128 a[44:47], v14 offset:45056
    v_mfma_f32_16x16x32_bf16 v[192:195], a[60:63], a[20:23], v[192:195]
    ds_read_b128 a[48:51], v14 offset:46080
    v_mfma_f32_16x16x32_bf16 v[196:199], a[60:63], a[24:27], v[196:199]
    s_waitcnt lgkmcnt(8)
    v_mfma_f32_16x16x32_bf16 v[200:203], a[64:67], a[0:3], v[200:203]
    s_waitcnt vmcnt(8)
    v_mfma_f32_16x16x32_bf16 v[204:207], a[64:67], a[4:7], v[204:207]
    ds_read_b64_tr_b16 a[56:57], v15 offset:8192
    v_mfma_f32_16x16x32_bf16 v[208:211], a[64:67], a[8:11], v[208:211]
    ds_read_b64_tr_b16 a[58:59], v15 offset:8704
    v_mfma_f32_16x16x32_bf16 v[212:215], a[64:67], a[12:15], v[212:215]
    ds_read_b128 a[52:55], v14 offset:47104
    v_mfma_f32_16x16x32_bf16 v[216:219], a[64:67], a[16:19], v[216:219]
    v_mfma_f32_16x16x32_bf16 v[220:223], a[64:67], a[20:23], v[220:223]
    v_mfma_f32_16x16x32_bf16 v[224:227], a[64:67], a[24:27], v[224:227]
    s_waitcnt lgkmcnt(6)
    v_mfma_f32_16x16x32_bf16 v[228:231], a[68:71], a[0:3], v[228:231]
    v_mfma_f32_16x16x32_bf16 v[232:235], a[68:71], a[4:7], v[232:235]
    ds_read_b64_tr_b16 a[60:61], v16 offset:8192
    v_mfma_f32_16x16x32_bf16 v[236:239], a[68:71], a[8:11], v[236:239]
    ds_read_b64_tr_b16 a[62:63], v16 offset:8704
    v_mfma_f32_16x16x32_bf16 v[240:243], a[68:71], a[12:15], v[240:243]
    v_mfma_f32_16x16x32_bf16 v[244:247], a[68:71], a[16:19], v[244:247]
    v_mfma_f32_16x16x32_bf16 v[248:251], a[68:71], a[20:23], v[248:251]
    v_mfma_f32_16x16x32_bf16 v[252:255], a[68:71], a[24:27], v[252:255]
    s_waitcnt lgkmcnt(2)
    v_mfma_f32_16x16x32_bf16 v[32:35], a[56:59], a[28:31], v[32:35]
    v_mfma_f32_16x16x32_bf16 v[36:39], a[56:59], a[32:35], v[36:39]
    ds_read_b64_tr_b16 a[64:65], v17 offset:8192
    v_mfma_f32_16x16x32_bf16 v[40:43], a[56:59], a[36:39], v[40:43]
    ds_read_b64_tr_b16 a[66:67], v17 offset:8704
    v_mfma_f32_16x16x32_bf16 v[44:47], a[56:59], a[40:43], v[44:47]
    v_mfma_f32_16x16x32_bf16 v[48:51], a[56:59], a[44:47], v[48:51]
    v_mfma_f32_16x16x32_bf16 v[52:55], a[56:59], a[48:51], v[52:55]
    v_mfma_f32_16x16x32_bf16 v[56:59], a[56:59], a[52:55], v[56:59]
    s_waitcnt lgkmcnt(2)
    v_mfma_f32_16x16x32_bf16 v[60:63], a[60:63], a[28:31], v[60:63]
    v_mfma_f32_16x16x32_bf16 v[64:67], a[60:63], a[32:35], v[64:67]
    ds_read_b64_tr_b16 a[68:69], v18 offset:8192
    v_mfma_f32_16x16x32_bf16 v[68:71], a[60:63], a[36:39], v[68:71]
    ds_read_b64_tr_b16 a[70:71], v18 offset:8704
    v_mfma_f32_16x16x32_bf16 v[72:75], a[60:63], a[40:43], v[72:75]
    v_mfma_f32_16x16x32_bf16 v[76:79], a[60:63], a[44:47], v[76:79]
    v_mfma_f32_16x16x32_bf16 v[80:83], a[60:63], a[48:51], v[80:83]
    v_mfma_f32_16x16x32_bf16 v[84:87], a[60:63], a[52:55], v[84:87]
    s_waitcnt lgkmcnt(2)
    v_mfma_f32_16x16x32_bf16 v[88:91], a[64:67], a[28:31], v[88:91]
    s_waitcnt vmcnt(0)
    v_mfma_f32_16x16x32_bf16 v[92:95], a[64:67], a[32:35], v[92:95]
    ds_read_b64_tr_b16 a[56:57], v15 offset:12288
    v_mfma_f32_16x16x32_bf16 v[96:99], a[64:67], a[36:39], v[96:99]
    ds_read_b64_tr_b16 a[58:59], v15 offset:12800
    v_mul_f32 v32, s39, v32
    v_mul_f32 v33, s39, v33
    v_mfma_f32_16x16x32_bf16 v[100:103], a[64:67], a[40:43], v[100:103]
    s_add_u32 m0, s32, 0
    s_mov_b32 s33, 0
    buffer_load_dwordx4 v1, s[16:19], s33 offen offset:0 nt lds
    v_mul_f32 v34, s39, v34
    v_mfma_f32_16x16x32_bf16 v[104:107], a[64:67], a[44:47], v[104:107]
    v_mul_f32 v35, s39, v35
    v_mul_f32 v60, s39, v60
    v_mfma_f32_16x16x32_bf16 v[108:111], a[64:67], a[48:51], v[108:111]
    buffer_load_dwordx4 v2, s[16:19], s33 offen offset:1024 nt lds
    v_mul_f32 v61, s39, v61
    v_mfma_f32_16x16x32_bf16 v[112:115], a[64:67], a[52:55], v[112:115]
    s_waitcnt lgkmcnt(2)
    v_mul_f32 v62, s39, v62
    v_mul_f32 v63, s39, v63
    v_mfma_f32_16x16x32_bf16 v[116:119], a[68:71], a[28:31], v[116:119]
    buffer_load_dwordx4 v3, s[16:19], s33 offen offset:2048 nt lds
    v_cvt_pk_bf16_f32 v32, v32, v33
    v_mfma_f32_16x16x32_bf16 v[120:123], a[68:71], a[32:35], v[120:123]
    ds_read_b64_tr_b16 a[60:61], v16 offset:12288
    v_cvt_pk_bf16_f32 v33, v34, v35
    v_cvt_pk_bf16_f32 v34, v60, v61
    v_mfma_f32_16x16x32_bf16 v[124:127], a[68:71], a[36:39], v[124:127]
    ds_read_b64_tr_b16 a[62:63], v16 offset:12800
    buffer_load_dwordx4 v4, s[16:19], s33 offen offset:3072 nt lds
    v_mfma_f32_16x16x32_bf16 v[128:131], a[68:71], a[40:43], v[128:131]
    v_cvt_pk_bf16_f32 v35, v62, v63
    v_mul_f32 v36, s39, v36
    v_mfma_f32_16x16x32_bf16 v[132:135], a[68:71], a[44:47], v[132:135]
    s_add_u32 m0, s32, 4096
    s_mov_b32 s33, 4096
    buffer_load_dwordx4 v1, s[16:19], s33 offen offset:0 nt lds
    v_mul_f32 v37, s39, v37
    v_mfma_f32_16x16x32_bf16 v[136:139], a[68:71], a[48:51], v[136:139]
    v_mul_f32 v38, s39, v38
    v_mul_f32 v39, s39, v39
    v_mfma_f32_16x16x32_bf16 v[140:143], a[68:71], a[52:55], v[140:143]
    s_waitcnt lgkmcnt(2)
    buffer_load_dwordx4 v2, s[16:19], s33 offen offset:1024 nt lds
    v_mfma_f32_16x16x32_bf16 v[144:147], a[56:59], a[28:31], v[144:147]
    v_mul_f32 v64, s39, v64
    v_mul_f32 v65, s39, v65
    v_mfma_f32_16x16x32_bf16 v[148:151], a[56:59], a[32:35], v[148:151]
    ds_read_b64_tr_b16 a[64:65], v17 offset:12288
    buffer_load_dwordx4 v3, s[16:19], s33 offen offset:2048 nt lds
    v_mfma_f32_16x16x32_bf16 v[152:155], a[56:59], a[36:39], v[152:155]
    ds_read_b64_tr_b16 a[66:67], v17 offset:12800
    v_mul_f32 v66, s39, v66
    v_mul_f32 v67, s39, v67
    v_mfma_f32_16x16x32_bf16 v[156:159], a[56:59], a[40:43], v[156:159]
    buffer_load_dwordx4 v4, s[16:19], s33 offen offset:3072 nt lds
    v_cvt_pk_bf16_f32 v36, v36, v37
    v_mfma_f32_16x16x32_bf16 v[160:163], a[56:59], a[44:47], v[160:163]
    v_cvt_pk_bf16_f32 v37, v38, v39
    v_cvt_pk_bf16_f32 v38, v64, v65
    v_mfma_f32_16x16x32_bf16 v[164:167], a[56:59], a[48:51], v[164:167]
    s_add_u32 m0, s32, 8192
    s_mov_b32 s33, 0
    buffer_load_dwordx4 v5, s[20:23], s33 offen offset:0 nt lds
    v_cvt_pk_bf16_f32 v39, v66, v67
    v_mfma_f32_16x16x32_bf16 v[168:171], a[56:59], a[52:55], v[168:171]
    s_waitcnt lgkmcnt(2)
    v_mul_f32 v40, s39, v40
    v_mul_f32 v41, s39, v41
    v_mfma_f32_16x16x32_bf16 v[172:175], a[60:63], a[28:31], v[172:175]
    buffer_load_dwordx4 v6, s[20:23], s33 offen offset:1024 nt lds
    v_mul_f32 v42, s39, v42
    v_mfma_f32_16x16x32_bf16 v[176:179], a[60:63], a[32:35], v[176:179]
    ds_read_b64_tr_b16 a[68:69], v18 offset:12288
    v_mul_f32 v43, s39, v43
    v_mul_f32 v68, s39, v68
    v_mfma_f32_16x16x32_bf16 v[180:183], a[60:63], a[36:39], v[180:183]
    ds_read_b64_tr_b16 a[70:71], v18 offset:12800
    buffer_load_dwordx4 v5, s[20:23], s33 offen offset:2048 nt lds
    v_mfma_f32_16x16x32_bf16 v[184:187], a[60:63], a[40:43], v[184:187]
    v_mul_f32 v69, s39, v69
    v_mul_f32 v70, s39, v70
    v_mfma_f32_16x16x32_bf16 v[188:191], a[60:63], a[44:47], v[188:191]
    buffer_load_dwordx4 v6, s[20:23], s33 offen offset:3072 nt lds
    v_mul_f32 v71, s39, v71
    v_mfma_f32_16x16x32_bf16 v[192:195], a[60:63], a[48:51], v[192:195]
    v_cvt_pk_bf16_f32 v40, v40, v41
    v_cvt_pk_bf16_f32 v41, v42, v43
    v_mfma_f32_16x16x32_bf16 v[196:199], a[60:63], a[52:55], v[196:199]
    s_waitcnt lgkmcnt(2)
    s_add_u32 m0, s32, 12288
    s_mov_b32 s33, 4096
    buffer_load_dwordx4 v5, s[20:23], s33 offen offset:0 nt lds
    v_mfma_f32_16x16x32_bf16 v[200:203], a[64:67], a[28:31], v[200:203]
    v_cvt_pk_bf16_f32 v42, v68, v69
    v_cvt_pk_bf16_f32 v43, v70, v71
    v_mfma_f32_16x16x32_bf16 v[204:207], a[64:67], a[32:35], v[204:207]
    buffer_load_dwordx4 v6, s[20:23], s33 offen offset:1024 nt lds
    v_mul_f32 v44, s39, v44
    v_mfma_f32_16x16x32_bf16 v[208:211], a[64:67], a[36:39], v[208:211]
    v_mul_f32 v45, s39, v45
    v_mul_f32 v46, s39, v46
    v_mfma_f32_16x16x32_bf16 v[212:215], a[64:67], a[40:43], v[212:215]
    buffer_load_dwordx4 v5, s[20:23], s33 offen offset:2048 nt lds
    v_mul_f32 v47, s39, v47
    v_mfma_f32_16x16x32_bf16 v[216:219], a[64:67], a[44:47], v[216:219]
    v_mul_f32 v72, s39, v72
    v_mul_f32 v73, s39, v73
    v_mfma_f32_16x16x32_bf16 v[220:223], a[64:67], a[48:51], v[220:223]
    buffer_load_dwordx4 v6, s[20:23], s33 offen offset:3072 nt lds
    v_mul_f32 v74, s39, v74
    v_mfma_f32_16x16x32_bf16 v[224:227], a[64:67], a[52:55], v[224:227]
    s_waitcnt lgkmcnt(0)
    v_mul_f32 v75, s39, v75
    v_cvt_pk_bf16_f32 v44, v44, v45
    v_mfma_f32_16x16x32_bf16 v[228:231], a[68:71], a[28:31], v[228:231]
    v_cvt_pk_bf16_f32 v45, v46, v47
    v_cvt_pk_bf16_f32 v46, v72, v73
    v_mfma_f32_16x16x32_bf16 v[232:235], a[68:71], a[32:35], v[232:235]
    v_cvt_pk_bf16_f32 v47, v74, v75
    v_mul_f32 v48, s39, v48
    v_mfma_f32_16x16x32_bf16 v[236:239], a[68:71], a[36:39], v[236:239]
    v_mul_f32 v49, s39, v49
    v_mul_f32 v50, s39, v50
    v_mfma_f32_16x16x32_bf16 v[240:243], a[68:71], a[40:43], v[240:243]
    v_mul_f32 v51, s39, v51
    v_mul_f32 v76, s39, v76
    v_mfma_f32_16x16x32_bf16 v[244:247], a[68:71], a[44:47], v[244:247]
    v_mul_f32 v77, s39, v77
    v_mul_f32 v78, s39, v78
    v_mfma_f32_16x16x32_bf16 v[248:251], a[68:71], a[48:51], v[248:251]
    v_mul_f32 v79, s39, v79
    v_cvt_pk_bf16_f32 v48, v48, v49
    v_mfma_f32_16x16x32_bf16 v[252:255], a[68:71], a[52:55], v[252:255]
    v_cvt_pk_bf16_f32 v49, v50, v51
    v_cvt_pk_bf16_f32 v50, v76, v77
    v_cvt_pk_bf16_f32 v51, v78, v79
    v_mul_f32 v52, s39, v52
    v_mul_f32 v53, s39, v53
    v_mul_f32 v54, s39, v54
    v_mul_f32 v55, s39, v55
    v_mul_f32 v80, s39, v80
    v_mul_f32 v81, s39, v81
    v_mul_f32 v82, s39, v82
    v_mul_f32 v83, s39, v83
    v_cvt_pk_bf16_f32 v52, v52, v53
    v_cvt_pk_bf16_f32 v53, v54, v55
    v_cvt_pk_bf16_f32 v54, v80, v81
    v_cvt_pk_bf16_f32 v55, v82, v83
    v_mul_f32 v56, s39, v56
    v_mul_f32 v57, s39, v57
    v_mul_f32 v58, s39, v58
    v_mul_f32 v59, s39, v59
    v_mul_f32 v84, s39, v84
    v_mul_f32 v85, s39, v85
    v_mul_f32 v86, s39, v86
    v_mul_f32 v87, s39, v87
    v_cvt_pk_bf16_f32 v56, v56, v57
    v_cvt_pk_bf16_f32 v57, v58, v59
    v_cvt_pk_bf16_f32 v58, v84, v85
    v_cvt_pk_bf16_f32 v59, v86, v87
    v_mul_f32 v88, s39, v88
    v_mul_f32 v89, s39, v89
    v_mul_f32 v90, s39, v90
    v_mul_f32 v91, s39, v91
    v_mul_f32 v116, s39, v116
    v_mul_f32 v117, s39, v117
    v_mul_f32 v118, s39, v118
    v_mul_f32 v119, s39, v119
    v_cvt_pk_bf16_f32 v60, v88, v89
    v_cvt_pk_bf16_f32 v61, v90, v91
    v_cvt_pk_bf16_f32 v62, v116, v117
    v_cvt_pk_bf16_f32 v63, v118, v119
    v_mul_f32 v92, s39, v92
    v_mul_f32 v93, s39, v93
    v_mul_f32 v94, s39, v94
    v_mul_f32 v95, s39, v95
    v_mul_f32 v120, s39, v120
    v_mul_f32 v121, s39, v121
    v_mul_f32 v122, s39, v122
    v_mul_f32 v123, s39, v123
    v_cvt_pk_bf16_f32 v64, v92, v93
    v_cvt_pk_bf16_f32 v65, v94, v95
    v_cvt_pk_bf16_f32 v66, v120, v121
    v_cvt_pk_bf16_f32 v67, v122, v123
    v_mul_f32 v96, s39, v96
    v_mul_f32 v97, s39, v97
    v_mul_f32 v98, s39, v98
    v_mul_f32 v99, s39, v99
    v_mul_f32 v124, s39, v124
    v_mul_f32 v125, s39, v125
    v_mul_f32 v126, s39, v126
    v_mul_f32 v127, s39, v127
    v_cvt_pk_bf16_f32 v68, v96, v97
    v_cvt_pk_bf16_f32 v69, v98, v99
    v_cvt_pk_bf16_f32 v70, v124, v125
    v_cvt_pk_bf16_f32 v71, v126, v127
    v_mul_f32 v100, s39, v100
    v_mul_f32 v101, s39, v101
    v_mul_f32 v102, s39, v102
    v_mul_f32 v103, s39, v103
    v_mul_f32 v128, s39, v128
    v_mul_f32 v129, s39, v129
    v_mul_f32 v130, s39, v130
    v_mul_f32 v131, s39, v131
    v_cvt_pk_bf16_f32 v72, v100, v101
    v_cvt_pk_bf16_f32 v73, v102, v103
    v_cvt_pk_bf16_f32 v74, v128, v129
    v_cvt_pk_bf16_f32 v75, v130, v131
    v_mul_f32 v104, s39, v104
    v_mul_f32 v105, s39, v105
    v_mul_f32 v106, s39, v106
    v_mul_f32 v107, s39, v107
    v_mul_f32 v132, s39, v132
    v_mul_f32 v133, s39, v133
    v_mul_f32 v134, s39, v134
    v_mul_f32 v135, s39, v135
    v_cvt_pk_bf16_f32 v76, v104, v105
    v_cvt_pk_bf16_f32 v77, v106, v107
    v_cvt_pk_bf16_f32 v78, v132, v133
    v_cvt_pk_bf16_f32 v79, v134, v135
    v_mul_f32 v108, s39, v108
    v_mul_f32 v109, s39, v109
    v_mul_f32 v110, s39, v110
    v_mul_f32 v111, s39, v111
    v_mul_f32 v136, s39, v136
    v_mul_f32 v137, s39, v137
    v_mul_f32 v138, s39, v138
    v_mul_f32 v139, s39, v139
    v_cvt_pk_bf16_f32 v80, v108, v109
    v_cvt_pk_bf16_f32 v81, v110, v111
    v_cvt_pk_bf16_f32 v82, v136, v137
    v_cvt_pk_bf16_f32 v83, v138, v139
    v_mul_f32 v112, s39, v112
    v_mul_f32 v113, s39, v113
    v_mul_f32 v114, s39, v114
    v_mul_f32 v115, s39, v115
    v_mul_f32 v140, s39, v140
    v_mul_f32 v141, s39, v141
    v_mul_f32 v142, s39, v142
    v_mul_f32 v143, s39, v143
    v_cvt_pk_bf16_f32 v84, v112, v113
    v_cvt_pk_bf16_f32 v85, v114, v115
    v_cvt_pk_bf16_f32 v86, v140, v141
    v_cvt_pk_bf16_f32 v87, v142, v143
    v_mul_f32 v144, s39, v144
    v_mul_f32 v145, s39, v145
    v_mul_f32 v146, s39, v146
    v_mul_f32 v147, s39, v147
    v_mul_f32 v172, s39, v172
    v_mul_f32 v173, s39, v173
    v_mul_f32 v174, s39, v174
    v_mul_f32 v175, s39, v175
    v_cvt_pk_bf16_f32 v88, v144, v145
    v_cvt_pk_bf16_f32 v89, v146, v147
    v_cvt_pk_bf16_f32 v90, v172, v173
    v_cvt_pk_bf16_f32 v91, v174, v175
    v_mul_f32 v148, s39, v148
    v_mul_f32 v149, s39, v149
    v_mul_f32 v150, s39, v150
    v_mul_f32 v151, s39, v151
    v_mul_f32 v176, s39, v176
    v_mul_f32 v177, s39, v177
    v_mul_f32 v178, s39, v178
    v_mul_f32 v179, s39, v179
    v_cvt_pk_bf16_f32 v92, v148, v149
    v_cvt_pk_bf16_f32 v93, v150, v151
    v_cvt_pk_bf16_f32 v94, v176, v177
    v_cvt_pk_bf16_f32 v95, v178, v179
    v_mul_f32 v152, s39, v152
    v_mul_f32 v153, s39, v153
    v_mul_f32 v154, s39, v154
    v_mul_f32 v155, s39, v155
    v_mul_f32 v180, s39, v180
    v_mul_f32 v181, s39, v181
    v_mul_f32 v182, s39, v182
    v_mul_f32 v183, s39, v183
    v_cvt_pk_bf16_f32 v96, v152, v153
    v_cvt_pk_bf16_f32 v97, v154, v155
    v_cvt_pk_bf16_f32 v98, v180, v181
    v_cvt_pk_bf16_f32 v99, v182, v183
    v_mul_f32 v156, s39, v156
    v_mul_f32 v157, s39, v157
    v_mul_f32 v158, s39, v158
    v_mul_f32 v159, s39, v159
    v_mul_f32 v184, s39, v184
    v_mul_f32 v185, s39, v185
    v_mul_f32 v186, s39, v186
    v_mul_f32 v187, s39, v187
    v_cvt_pk_bf16_f32 v100, v156, v157
    v_cvt_pk_bf16_f32 v101, v158, v159
    v_cvt_pk_bf16_f32 v102, v184, v185
    v_cvt_pk_bf16_f32 v103, v186, v187
    v_mul_f32 v160, s39, v160
    v_mul_f32 v161, s39, v161
    v_mul_f32 v162, s39, v162
    v_mul_f32 v163, s39, v163
    v_mul_f32 v188, s39, v188
    v_mul_f32 v189, s39, v189
    v_mul_f32 v190, s39, v190
    v_mul_f32 v191, s39, v191
    v_cvt_pk_bf16_f32 v104, v160, v161
    v_cvt_pk_bf16_f32 v105, v162, v163
    v_cvt_pk_bf16_f32 v106, v188, v189
    v_cvt_pk_bf16_f32 v107, v190, v191
    v_mul_f32 v164, s39, v164
    v_mul_f32 v165, s39, v165
    v_mul_f32 v166, s39, v166
    v_mul_f32 v167, s39, v167
    v_mul_f32 v192, s39, v192
    v_mul_f32 v193, s39, v193
    v_mul_f32 v194, s39, v194
    v_mul_f32 v195, s39, v195
    v_cvt_pk_bf16_f32 v108, v164, v165
    v_cvt_pk_bf16_f32 v109, v166, v167
    v_cvt_pk_bf16_f32 v110, v192, v193
    v_cvt_pk_bf16_f32 v111, v194, v195
    v_mul_f32 v168, s39, v168
    v_mul_f32 v169, s39, v169
    v_mul_f32 v170, s39, v170
    v_mul_f32 v171, s39, v171
    v_mul_f32 v196, s39, v196
    v_mul_f32 v197, s39, v197
    v_mul_f32 v198, s39, v198
    v_mul_f32 v199, s39, v199
    v_cvt_pk_bf16_f32 v17, v168, v169
    v_cvt_pk_bf16_f32 v18, v170, v171
    v_cvt_pk_bf16_f32 v19, v196, v197
    v_cvt_pk_bf16_f32 v20, v198, v199
    v_accvgpr_write_b32 a224, v17
    v_accvgpr_write_b32 a225, v18
    v_accvgpr_write_b32 a226, v19
    v_accvgpr_write_b32 a227, v20
    s_waitcnt lgkmcnt(0)
    s_barrier
    v_mul_f32 v200, s39, v200
    v_mul_f32 v201, s39, v201
    v_mul_f32 v202, s39, v202
    v_mul_f32 v203, s39, v203
    v_mul_f32 v228, s39, v228
    v_mul_f32 v229, s39, v229
    v_mul_f32 v230, s39, v230
    v_mul_f32 v231, s39, v231
    v_cvt_pk_bf16_f32 v17, v200, v201
    v_cvt_pk_bf16_f32 v18, v202, v203
    v_cvt_pk_bf16_f32 v19, v228, v229
    v_cvt_pk_bf16_f32 v20, v230, v231
    v_accvgpr_write_b32 a228, v17
    v_accvgpr_write_b32 a229, v18
    v_accvgpr_write_b32 a230, v19
    v_accvgpr_write_b32 a231, v20
    v_mul_f32 v204, s39, v204
    v_mul_f32 v205, s39, v205
    v_mul_f32 v206, s39, v206
    v_mul_f32 v207, s39, v207
    v_mul_f32 v232, s39, v232
    v_mul_f32 v233, s39, v233
    v_mul_f32 v234, s39, v234
    v_mul_f32 v235, s39, v235
    v_cvt_pk_bf16_f32 v17, v204, v205
    v_cvt_pk_bf16_f32 v18, v206, v207
    v_cvt_pk_bf16_f32 v19, v232, v233
    v_cvt_pk_bf16_f32 v20, v234, v235
    v_accvgpr_write_b32 a232, v17
    v_accvgpr_write_b32 a233, v18
    v_accvgpr_write_b32 a234, v19
    v_accvgpr_write_b32 a235, v20
    v_mul_f32 v208, s39, v208
    v_mul_f32 v209, s39, v209
    v_mul_f32 v210, s39, v210
    v_mul_f32 v211, s39, v211
    v_mul_f32 v236, s39, v236
    v_mul_f32 v237, s39, v237
    v_mul_f32 v238, s39, v238
    v_mul_f32 v239, s39, v239
    v_cvt_pk_bf16_f32 v17, v208, v209
    v_cvt_pk_bf16_f32 v18, v210, v211
    v_cvt_pk_bf16_f32 v19, v236, v237
    v_cvt_pk_bf16_f32 v20, v238, v239
    v_accvgpr_write_b32 a236, v17
    v_accvgpr_write_b32 a237, v18
    v_accvgpr_write_b32 a238, v19
    v_accvgpr_write_b32 a239, v20
    v_mul_f32 v212, s39, v212
    v_mul_f32 v213, s39, v213
    v_mul_f32 v214, s39, v214
    v_mul_f32 v215, s39, v215
    v_mul_f32 v240, s39, v240
    v_mul_f32 v241, s39, v241
    v_mul_f32 v242, s39, v242
    v_mul_f32 v243, s39, v243
    v_cvt_pk_bf16_f32 v17, v212, v213
    v_cvt_pk_bf16_f32 v18, v214, v215
    v_cvt_pk_bf16_f32 v19, v240, v241
    v_cvt_pk_bf16_f32 v20, v242, v243
    v_accvgpr_write_b32 a240, v17
    v_accvgpr_write_b32 a241, v18
    v_accvgpr_write_b32 a242, v19
    v_accvgpr_write_b32 a243, v20
    v_mul_f32 v216, s39, v216
    v_mul_f32 v217, s39, v217
    v_mul_f32 v218, s39, v218
    v_mul_f32 v219, s39, v219
    v_mul_f32 v244, s39, v244
    v_mul_f32 v245, s39, v245
    v_mul_f32 v246, s39, v246
    v_mul_f32 v247, s39, v247
    v_cvt_pk_bf16_f32 v17, v216, v217
    v_cvt_pk_bf16_f32 v18, v218, v219
    v_cvt_pk_bf16_f32 v19, v244, v245
    v_cvt_pk_bf16_f32 v20, v246, v247
    v_accvgpr_write_b32 a244, v17
    v_accvgpr_write_b32 a245, v18
    v_accvgpr_write_b32 a246, v19
    v_accvgpr_write_b32 a247, v20
    v_mul_f32 v220, s39, v220
    v_mul_f32 v221, s39, v221
    v_mul_f32 v222, s39, v222
    v_mul_f32 v223, s39, v223
    v_mul_f32 v248, s39, v248
    v_mul_f32 v249, s39, v249
    v_mul_f32 v250, s39, v250
    v_mul_f32 v251, s39, v251
    v_cvt_pk_bf16_f32 v17, v220, v221
    v_cvt_pk_bf16_f32 v18, v222, v223
    v_cvt_pk_bf16_f32 v19, v248, v249
    v_cvt_pk_bf16_f32 v20, v250, v251
    v_accvgpr_write_b32 a248, v17
    v_accvgpr_write_b32 a249, v18
    v_accvgpr_write_b32 a250, v19
    v_accvgpr_write_b32 a251, v20
    v_mul_f32 v224, s39, v224
    v_mul_f32 v225, s39, v225
    v_mul_f32 v226, s39, v226
    v_mul_f32 v227, s39, v227
    v_mul_f32 v252, s39, v252
    v_mul_f32 v253, s39, v253
    v_mul_f32 v254, s39, v254
    v_mul_f32 v255, s39, v255
    v_cvt_pk_bf16_f32 v17, v224, v225
    v_cvt_pk_bf16_f32 v18, v226, v227
    v_cvt_pk_bf16_f32 v19, v252, v253
    v_cvt_pk_bf16_f32 v20, v254, v255
    v_accvgpr_write_b32 a252, v17
    v_accvgpr_write_b32 a253, v18
    v_accvgpr_write_b32 a254, v19
    v_accvgpr_write_b32 a255, v20
    v_mov_b32 v18, 0
    v_mov_b32 v19, 0
    v_mov_b32 v20, 0
    v_mov_b32 v21, 0
    s_nop 1
    v_mfma_f32_32x32x16_bf16 a[0:15], v[18:21], v[18:21], 0
    v_mfma_f32_32x32x16_bf16 a[16:31], v[18:21], v[18:21], 0
    v_mfma_f32_32x32x16_bf16 a[32:47], v[18:21], v[18:21], 0
    v_mfma_f32_32x32x16_bf16 a[48:63], v[18:21], v[18:21], 0
    v_mfma_f32_32x32x16_bf16 a[64:79], v[18:21], v[18:21], 0
    v_mfma_f32_32x32x16_bf16 v[212:227], v[18:21], v[18:21], 0
    v_mfma_f32_32x32x16_bf16 v[224:239], v[18:21], v[18:21], 0
    s_nop 7
    s_mov_b64 s[42:43], -1
    s_mul_i32 s6, s51, 1179648
    s_add_u32 s84, s80, s6
    s_addc_u32 s85, s81, 0
    s_and_b32 s85, s85, 0xffff
    s_mov_b32 s86, 1179648
    s_mov_b32 s87, 0x20000
    s_lshl_b32 s6, s57, 7
    v_lshlrev_b32 v17, 7, v0
    v_mov_b32 v18, 0x7fffff00
    v_cmp_gt_u32 vcc, 36, v0
    s_nop 1
    v_cndmask_b32 v17, v18, v17, vcc
    buffer_load_dword v240, v17, s[84:87], s6 offen
    s_add_u32 s6, s6, 4608
    buffer_load_dword v240, v17, s[84:87], s6 offen
    s_add_u32 s44, s32, 24576
    s_add_u32 m0, s32, 16384
    s_mov_b32 s33, 8192
    buffer_load_dwordx4 v1, s[16:19], s33 offen offset:0 nt lds
    buffer_load_dwordx4 v2, s[16:19], s33 offen offset:1024 nt lds
    buffer_load_dwordx4 v3, s[16:19], s33 offen offset:2048 nt lds
    buffer_load_dwordx4 v4, s[16:19], s33 offen offset:3072 nt lds
    s_add_u32 m0, s32, 20480
    s_mov_b32 s33, 12288
    buffer_load_dwordx4 v1, s[16:19], s33 offen offset:0 nt lds
    buffer_load_dwordx4 v2, s[16:19], s33 offen offset:1024 nt lds
    buffer_load_dwordx4 v3, s[16:19], s33 offen offset:2048 nt lds
    buffer_load_dwordx4 v4, s[16:19], s33 offen offset:3072 nt lds
    s_mov_b32 s36, s32
    s_waitcnt vmcnt(18)
    v_add_u32 v21, s36, v7
    v_xor_b32 v9, 0, v21
    v_xor_b32 v10, 32, v21
    v_xor_b32 v11, 64, v21
    v_xor_b32 v12, 96, v21
    v_xor_b32 v13, 128, v21
    v_xor_b32 v14, 160, v21
    v_xor_b32 v15, 192, v21
    v_xor_b32 v16, 224, v21
    ds_read_b64 v[112:113], v9 offset:0
    ds_read_b64 v[114:115], v10 offset:0
    ds_read_b64 v[116:117], v11 offset:0
    ds_read_b64 v[118:119], v12 offset:0
    ds_read_b64 v[120:121], v13 offset:0
    ds_read_b64 v[122:123], v14 offset:0
    ds_read_b64 v[124:125], v15 offset:0
    ds_read_b64 v[126:127], v16 offset:0
    ds_read_b64 v[128:129], v9 offset:4096
    ds_read_b64 v[130:131], v10 offset:4096
    ds_read_b64 v[132:133], v11 offset:4096
    ds_read_b64 v[134:135], v12 offset:4096
    ds_read_b64 v[136:137], v13 offset:4096
    ds_read_b64 v[138:139], v14 offset:4096
    ds_read_b64 v[140:141], v15 offset:4096
    ds_read_b64 v[142:143], v16 offset:4096
    s_waitcnt lgkmcnt(0)
    s_mov_b32 s37, 8192
    s_add_u32 m0, s36, 0
    s_add_u32 s33, s37, 0
    buffer_load_dwordx4 v5, s[20:23], s33 offen offset:0 nt lds
    buffer_load_dwordx4 v6, s[20:23], s33 offen offset:1024 nt lds
    buffer_load_dwordx4 v5, s[20:23], s33 offen offset:2048 nt lds
    buffer_load_dwordx4 v6, s[20:23], s33 offen offset:3072 nt lds
    s_add_u32 m0, s36, 4096
    s_add_u32 s33, s37, 4096
    buffer_load_dwordx4 v5, s[20:23], s33 offen offset:0 nt lds
    buffer_load_dwordx4 v6, s[20:23], s33 offen offset:1024 nt lds
    buffer_load_dwordx4 v5, s[20:23], s33 offen offset:2048 nt lds
    buffer_load_dwordx4 v6, s[20:23], s33 offen offset:3072 nt lds
    s_add_u32 s36, s36, 8192
    s_cmp_eq_u32 s36, s44
    s_cselect_b32 s36, s32, s36
    v_mfma_f32_16x16x32_bf16 v[176:179], v[112:115], v[32:35], v[212:215]
    v_mfma_f32_16x16x32_bf16 v[180:183], v[128:131], v[32:35], v[212:215]
    v_mfma_f32_16x16x32_bf16 v[176:179], v[116:119], v[60:63], v[176:179]
    v_mfma_f32_16x16x32_bf16 v[180:183], v[132:135], v[60:63], v[180:183]
    v_mfma_f32_16x16x32_bf16 v[176:179], v[120:123], v[88:91], v[176:179]
    v_mfma_f32_16x16x32_bf16 v[180:183], v[136:139], v[88:91], v[180:183]
    v_mfma_f32_16x16x32_bf16 v[176:179], v[124:127], a[228:231], v[176:179]
    v_mfma_f32_16x16x32_bf16 v[180:183], v[140:143], a[228:231], v[180:183]
    s_mov_b32 s35, 0
    s_mov_b32 s37, 16384
    s_nop 7
L_Aa:
    v_mfma_f32_16x16x32_bf16 v[184:187], v[112:115], v[36:39], v[216:219]
    v_exp_f32 v17, v176
    v_mfma_f32_16x16x32_bf16 v[188:191], v[128:131], v[36:39], v[216:219]
    s_waitcnt vmcnt(16)
    v_add_u32 v21, s36, v8
    v_xor_b32 v9, 0, v21
    v_xor_b32 v10, 32, v21
    v_xor_b32 v11, 64, v21
    v_xor_b32 v12, 96, v21
    v_xor_b32 v13, 128, v21
    v_xor_b32 v14, 160, v21
    v_xor_b32 v15, 192, v21
    v_xor_b32 v16, 224, v21
    ds_read_b64_tr_b16 v[144:145], v9 offset:0
    ds_read_b64_tr_b16 v[146:147], v9 offset:4096
    ds_read_b64_tr_b16 v[148:149], v10 offset:0
    ds_read_b64_tr_b16 v[150:151], v10 offset:4096
    ds_read_b64_tr_b16 v[152:153], v11 offset:0
    ds_read_b64_tr_b16 v[154:155], v11 offset:4096
    ds_read_b64_tr_b16 v[156:157], v12 offset:0
    ds_read_b64_tr_b16 v[158:159], v12 offset:4096
    ds_read_b64_tr_b16 v[160:161], v13 offset:0
    ds_read_b64_tr_b16 v[162:163], v13 offset:4096
    ds_read_b64_tr_b16 v[164:165], v14 offset:0
    ds_read_b64_tr_b16 v[166:167], v14 offset:4096
    ds_read_b64_tr_b16 v[168:169], v15 offset:0
    ds_read_b64_tr_b16 v[170:171], v15 offset:4096
    ds_read_b64_tr_b16 v[172:173], v16 offset:0
    ds_read_b64_tr_b16 v[174:175], v16 offset:4096
    v_mfma_f32_16x16x32_bf16 v[184:187], v[116:119], v[64:67], v[184:187]
    v_exp_f32 v18, v177
    v_mfma_f32_16x16x32_bf16 v[188:191], v[132:135], v[64:67], v[188:191]
    v_exp_f32 v19, v178
    v_mfma_f32_16x16x32_bf16 v[184:187], v[120:123], v[92:95], v[184:187]
    v_exp_f32 v20, v179
    v_mfma_f32_16x16x32_bf16 v[188:191], v[136:139], v[92:95], v[188:191]
    v_add_f32 v23, v17, v18
    v_cvt_pk_bf16_f32 v200, v17, v18
    v_mfma_f32_16x16x32_bf16 v[184:187], v[124:127], a[232:235], v[184:187]
    v_exp_f32 v17, v180
    v_exp_f32 v18, v181
    v_add_f32 v23, v23, v19
    v_add_f32 v23, v23, v20
    v_cvt_pk_bf16_f32 v201, v19, v20
    v_exp_f32 v19, v182
    v_exp_f32 v20, v183
    v_add_f32 v23, v23, v17
    v_add_f32 v23, v23, v18
    v_cvt_pk_bf16_f32 v202, v17, v18
    s_nop 0
    v_add_f32 v23, v23, v19
    v_add_f32 v23, v23, v20
    v_cvt_pk_bf16_f32 v203, v19, v20
    v_cmp_nge_f32 vcc, s38, v23
    s_or_b64 vcc, vcc, s[42:43]
    s_cbranch_vccnz L_rarea_0
L_rarea_0_ret:
    v_add_f32 v24, v24, v23
    v_mfma_f32_16x16x32_bf16 v[188:191], v[140:143], a[232:235], v[188:191]
    s_waitcnt lgkmcnt(0)
    s_add_u32 m0, s36, 0
    s_add_u32 s33, s37, 0
    buffer_load_dwordx4 v1, s[16:19], s33 offen offset:0 nt lds
    buffer_load_dwordx4 v2, s[16:19], s33 offen offset:1024 nt lds
    buffer_load_dwordx4 v3, s[16:19], s33 offen offset:2048 nt lds
    buffer_load_dwordx4 v4, s[16:19], s33 offen offset:3072 nt lds
    s_add_u32 m0, s36, 4096
    s_add_u32 s33, s37, 4096
    buffer_load_dwordx4 v1, s[16:19], s33 offen offset:0 nt lds
    buffer_load_dwordx4 v2, s[16:19], s33 offen offset:1024 nt lds
    buffer_load_dwordx4 v3, s[16:19], s33 offen offset:2048 nt lds
    buffer_load_dwordx4 v4, s[16:19], s33 offen offset:3072 nt lds
    s_add_u32 s36, s36, 8192
    s_cmp_eq_u32 s36, s44
    s_cselect_b32 s36, s32, s36
    v_mfma_f32_16x16x32_bf16 a[0:3], v[144:147], v[200:203], a[0:3]
    v_mfma_f32_16x16x32_bf16 a[28:31], v[148:151], v[200:203], a[28:31]
    v_mfma_f32_16x16x32_bf16 a[56:59], v[152:155], v[200:203], a[56:59]
    v_exp_f32 v17, v184
    v_mfma_f32_16x16x32_bf16 a[84:87], v[156:159], v[200:203], a[84:87]
    v_exp_f32 v18, v185
    v_mfma_f32_16x16x32_bf16 a[112:115], v[160:163], v[200:203], a[112:115]
    v_exp_f32 v19, v186
    v_mfma_f32_16x16x32_bf16 a[140:143], v[164:167], v[200:203], a[140:143]
    v_exp_f32 v20, v187
    v_mfma_f32_16x16x32_bf16 a[168:171], v[168:171], v[200:203], a[168:171]
    v_add_f32 v23, v17, v18
    v_cvt_pk_bf16_f32 v204, v17, v18
    v_mfma_f32_16x16x32_bf16 a[196:199], v[172:175], v[200:203], a[196:199]
    v_exp_f32 v17, v188
    v_mfma_f32_16x16x32_bf16 v[192:195], v[112:115], v[40:43], v[220:223]
    v_exp_f32 v18, v189
    v_mfma_f32_16x16x32_bf16 v[196:199], v[128:131], v[40:43], v[220:223]
    v_add_f32 v23, v23, v19
    v_add_f32 v23, v23, v20
    v_mfma_f32_16x16x32_bf16 v[192:195], v[116:119], v[68:71], v[192:195]
    v_cvt_pk_bf16_f32 v205, v19, v20
    v_mfma_f32_16x16x32_bf16 v[196:199], v[132:135], v[68:71], v[196:199]
    v_exp_f32 v19, v190
    v_mfma_f32_16x16x32_bf16 v[192:195], v[120:123], v[96:99], v[192:195]
    v_exp_f32 v20, v191
    v_mfma_f32_16x16x32_bf16 v[196:199], v[136:139], v[96:99], v[196:199]
    v_add_f32 v23, v23, v17
    v_add_f32 v23, v23, v18
    v_mfma_f32_16x16x32_bf16 v[192:195], v[124:127], a[236:239], v[192:195]
    v_cvt_pk_bf16_f32 v206, v17, v18
    s_nop 0
    v_add_f32 v23, v23, v19
    v_add_f32 v23, v23, v20
    v_cvt_pk_bf16_f32 v207, v19, v20
    v_cmp_nge_f32 vcc, s38, v23
    s_or_b64 vcc, vcc, s[42:43]
    s_cbranch_vccnz L_rarea_1
L_rarea_1_ret:
    v_add_f32 v25, v25, v23
    v_mfma_f32_16x16x32_bf16 v[196:199], v[140:143], a[236:239], v[196:199]
    v_mfma_f32_16x16x32_bf16 a[4:7], v[144:147], v[204:207], a[4:7]
    v_mfma_f32_16x16x32_bf16 a[32:35], v[148:151], v[204:207], a[32:35]
    v_mfma_f32_16x16x32_bf16 a[60:63], v[152:155], v[204:207], a[60:63]
    v_exp_f32 v17, v192
    v_mfma_f32_16x16x32_bf16 a[88:91], v[156:159], v[204:207], a[88:91]
    v_exp_f32 v18, v193
    v_mfma_f32_16x16x32_bf16 a[116:119], v[160:163], v[204:207], a[116:119]
    v_exp_f32 v19, v194
    v_mfma_f32_16x16x32_bf16 a[144:147], v[164:167], v[204:207], a[144:147]
    v_exp_f32 v20, v195
    v_mfma_f32_16x16x32_bf16 a[172:175], v[168:171], v[204:207], a[172:175]
    v_add_f32 v23, v17, v18
    v_cvt_pk_bf16_f32 v208, v17, v18
    v_mfma_f32_16x16x32_bf16 a[200:203], v[172:175], v[204:207], a[200:203]
    v_exp_f32 v17, v196
    v_mfma_f32_16x16x32_bf16 v[184:187], v[112:115], v[44:47], v[224:227]
    v_exp_f32 v18, v197
    v_mfma_f32_16x16x32_bf16 v[188:191], v[128:131], v[44:47], v[224:227]
    v_add_f32 v23, v23, v19
    v_add_f32 v23, v23, v20
    v_mfma_f32_16x16x32_bf16 v[184:187], v[116:119], v[72:75], v[184:187]
    v_cvt_pk_bf16_f32 v209, v19, v20
    v_mfma_f32_16x16x32_bf16 v[188:191], v[132:135], v[72:75], v[188:191]
    v_exp_f32 v19, v198
    v_mfma_f32_16x16x32_bf16 v[184:187], v[120:123], v[100:103], v[184:187]
    v_exp_f32 v20, v199
    v_mfma_f32_16x16x32_bf16 v[188:191], v[136:139], v[100:103], v[188:191]
    v_add_f32 v23, v23, v17
    v_add_f32 v23, v23, v18
    v_mfma_f32_16x16x32_bf16 v[184:187], v[124:127], a[240:243], v[184:187]
    v_cvt_pk_bf16_f32 v210, v17, v18
    s_nop 0
    v_add_f32 v23, v23, v19
    v_add_f32 v23, v23, v20
    v_cvt_pk_bf16_f32 v211, v19, v20
    v_cmp_nge_f32 vcc, s38, v23
    s_or_b64 vcc, vcc, s[42:43]
    s_cbranch_vccnz L_rarea_2
L_rarea_2_ret:
    v_add_f32 v26, v26, v23
    v_mfma_f32_16x16x32_bf16 v[188:191], v[140:143], a[240:243], v[188:191]
    v_mfma_f32_16x16x32_bf16 a[8:11], v[144:147], v[208:211], a[8:11]
    v_mfma_f32_16x16x32_bf16 a[36:39], v[148:151], v[208:211], a[36:39]
    v_mfma_f32_16x16x32_bf16 a[64:67], v[152:155], v[208:211], a[64:67]
    v_exp_f32 v17, v184
    v_mfma_f32_16x16x32_bf16 a[92:95], v[156:159], v[208:211], a[92:95]
    v_exp_f32 v18, v185
    v_mfma_f32_16x16x32_bf16 a[120:123], v[160:163], v[208:211], a[120:123]
    v_exp_f32 v19, v186
    v_mfma_f32_16x16x32_bf16 a[148:151], v[164:167], v[208:211], a[148:151]
    v_exp_f32 v20, v187
    v_mfma_f32_16x16x32_bf16 a[176:179], v[168:171], v[208:211], a[176:179]
    v_add_f32 v23, v17, v18
    v_cvt_pk_bf16_f32 v204, v17, v18
    v_mfma_f32_16x16x32_bf16 a[204:207], v[172:175], v[208:211], a[204:207]
    v_exp_f32 v17, v188
    v_mfma_f32_16x16x32_bf16 v[192:195], v[112:115], v[48:51], v[228:231]
    v_exp_f32 v18, v189
    v_mfma_f32_16x16x32_bf16 v[196:199], v[128:131], v[48:51], v[228:231]
    v_add_f32 v23, v23, v19
    v_add_f32 v23, v23, v20
    v_mfma_f32_16x16x32_bf16 v[192:195], v[116:119], v[76:79], v[192:195]
    v_cvt_pk_bf16_f32 v205, v19, v20
    v_mfma_f32_16x16x32_bf16 v[196:199], v[132:135], v[76:79], v[196:199]
    v_exp_f32 v19, v190
    v_mfma_f32_16x16x32_bf16 v[192:195], v[120:123], v[104:107], v[192:195]
    v_exp_f32 v20, v191
    v_mfma_f32_16x16x32_bf16 v[196:199], v[136:139], v[104:107], v[196:199]
    v_add_f32 v23, v23, v17
    v_add_f32 v23, v23, v18
    v_mfma_f32_16x16x32_bf16 v[192:195], v[124:127], a[244:247], v[192:195]
    v_cvt_pk_bf16_f32 v206, v17, v18
    s_nop 0
    v_add_f32 v23, v23, v19
    v_add_f32 v23, v23, v20
    v_cvt_pk_bf16_f32 v207, v19, v20
    v_cmp_nge_f32 vcc, s38, v23
    s_or_b64 vcc, vcc, s[42:43]
    s_cbranch_vccnz L_rarea_3
L_rarea_3_ret:
    v_add_f32 v27, v27, v23
    v_mfma_f32_16x16x32_bf16 v[196:199], v[140:143], a[244:247], v[196:199]
    v_mfma_f32_16x16x32_bf16 a[12:15], v[144:147], v[204:207], a[12:15]
    v_mfma_f32_16x16x32_bf16 a[40:43], v[148:151], v[204:207], a[40:43]
    v_mfma_f32_16x16x32_bf16 a[68:71], v[152:155], v[204:207], a[68:71]
    v_exp_f32 v17, v192
    v_mfma_f32_16x16x32_bf16 a[96:99], v[156:159], v[204:207], a[96:99]
    v_exp_f32 v18, v193
    v_mfma_f32_16x16x32_bf16 a[124:127], v[160:163], v[204:207], a[124:127]
    v_exp_f32 v19, v194
    v_mfma_f32_16x16x32_bf16 a[152:155], v[164:167], v[204:207], a[152:155]
    v_exp_f32 v20, v195
    v_mfma_f32_16x16x32_bf16 a[180:183], v[168:171], v[204:207], a[180:183]
    v_add_f32 v23, v17, v18
    v_cvt_pk_bf16_f32 v208, v17, v18
    v_mfma_f32_16x16x32_bf16 a[208:211], v[172:175], v[204:207], a[208:211]
    v_exp_f32 v17, v196
    v_mfma_f32_16x16x32_bf16 v[184:187], v[112:115], v[52:55], v[232:235]
    v_exp_f32 v18, v197
    v_mfma_f32_16x16x32_bf16 v[188:191], v[128:131], v[52:55], v[232:235]
    v_add_f32 v23, v23, v19
    v_add_f32 v23, v23, v20
    v_mfma_f32_16x16x32_bf16 v[184:187], v[116:119], v[80:83], v[184:187]
    v_cvt_pk_bf16_f32 v209, v19, v20
    v_mfma_f32_16x16x32_bf16 v[188:191], v[132:135], v[80:83], v[188:191]
    v_exp_f32 v19, v198
    v_mfma_f32_16x16x32_bf16 v[184:187], v[120:123], v[108:111], v[184:187]
    v_exp_f32 v20, v199
    v_mfma_f32_16x16x32_bf16 v[188:191], v[136:139], v[108:111], v[188:191]
    v_add_f32 v23, v23, v17
    v_add_f32 v23, v23, v18
    v_mfma_f32_16x16x32_bf16 v[184:187], v[124:127], a[248:251], v[184:187]
    v_cvt_pk_bf16_f32 v210, v17, v18
    s_nop 0
    v_add_f32 v23, v23, v19
    v_add_f32 v23, v23, v20
    v_cvt_pk_bf16_f32 v211, v19, v20
    v_cmp_nge_f32 vcc, s38, v23
    s_or_b64 vcc, vcc, s[42:43]
    s_cbranch_vccnz L_rarea_4
L_rarea_4_ret:
    v_add_f32 v28, v28, v23
    v_mfma_f32_16x16x32_bf16 v[188:191], v[140:143], a[248:251], v[188:191]
    v_mfma_f32_16x16x32_bf16 a[16:19], v[144:147], v[208:211], a[16:19]
    v_mfma_f32_16x16x32_bf16 a[44:47], v[148:151], v[208:211], a[44:47]
    v_mfma_f32_16x16x32_bf16 a[72:75], v[152:155], v[208:211], a[72:75]
    v_exp_f32 v17, v184
    v_mfma_f32_16x16x32_bf16 a[100:103], v[156:159], v[208:211], a[100:103]
    v_exp_f32 v18, v185
    v_mfma_f32_16x16x32_bf16 a[128:131], v[160:163], v[208:211], a[128:131]
    v_exp_f32 v19, v186
    v_mfma_f32_16x16x32_bf16 a[156:159], v[164:167], v[208:211], a[156:159]
    v_exp_f32 v20, v187
    v_mfma_f32_16x16x32_bf16 a[184:187], v[168:171], v[208:211], a[184:187]
    v_add_f32 v23, v17, v18
    v_cvt_pk_bf16_f32 v204, v17, v18
    v_mfma_f32_16x16x32_bf16 a[212:215], v[172:175], v[208:211], a[212:215]
    v_exp_f32 v17, v188
    v_mfma_f32_16x16x32_bf16 v[192:195], v[112:115], v[56:59], v[236:239]
    v_exp_f32 v18, v189
    v_mfma_f32_16x16x32_bf16 v[196:199], v[128:131], v[56:59], v[236:239]
    v_add_f32 v23, v23, v19
    v_add_f32 v23, v23, v20
    v_mfma_f32_16x16x32_bf16 v[192:195], v[116:119], v[84:87], v[192:195]
    v_cvt_pk_bf16_f32 v205, v19, v20
    v_mfma_f32_16x16x32_bf16 v[196:199], v[132:135], v[84:87], v[196:199]
    v_exp_f32 v19, v190
    v_mfma_f32_16x16x32_bf16 v[192:195], v[120:123], a[224:227], v[192:195]
    v_exp_f32 v20, v191
    v_mfma_f32_16x16x32_bf16 v[196:199], v[136:139], a[224:227], v[196:199]
    v_add_f32 v23, v23, v17
    v_add_f32 v23, v23, v18
    v_mfma_f32_16x16x32_bf16 v[192:195], v[124:127], a[252:255], v[192:195]
    v_cvt_pk_bf16_f32 v206, v17, v18
    s_nop 0
    v_add_f32 v23, v23, v19
    v_add_f32 v23, v23, v20
    v_cvt_pk_bf16_f32 v207, v19, v20
    v_cmp_nge_f32 vcc, s38, v23
    s_or_b64 vcc, vcc, s[42:43]
    s_cbranch_vccnz L_rarea_5
L_rarea_5_ret:
    v_add_f32 v29, v29, v23
    v_mfma_f32_16x16x32_bf16 v[196:199], v[140:143], a[252:255], v[196:199]
    s_waitcnt vmcnt(16)
    v_add_u32 v21, s36, v7
    v_xor_b32 v9, 0, v21
    v_xor_b32 v10, 32, v21
    v_xor_b32 v11, 64, v21
    v_xor_b32 v12, 96, v21
    v_xor_b32 v13, 128, v21
    v_xor_b32 v14, 160, v21
    v_xor_b32 v15, 192, v21
    v_xor_b32 v16, 224, v21
    ds_read_b64 v[112:113], v9 offset:0
    ds_read_b64 v[114:115], v10 offset:0
    ds_read_b64 v[116:117], v11 offset:0
    ds_read_b64 v[118:119], v12 offset:0
    ds_read_b64 v[120:121], v13 offset:0
    ds_read_b64 v[122:123], v14 offset:0
    ds_read_b64 v[124:125], v15 offset:0
    ds_read_b64 v[126:127], v16 offset:0
    ds_read_b64 v[128:129], v9 offset:4096
    ds_read_b64 v[130:131], v10 offset:4096
    ds_read_b64 v[132:133], v11 offset:4096
    ds_read_b64 v[134:135], v12 offset:4096
    ds_read_b64 v[136:137], v13 offset:4096
    ds_read_b64 v[138:139], v14 offset:4096
    ds_read_b64 v[140:141], v15 offset:4096
    ds_read_b64 v[142:143], v16 offset:4096
    v_mfma_f32_16x16x32_bf16 a[20:23], v[144:147], v[204:207], a[20:23]
    v_mfma_f32_16x16x32_bf16 a[48:51], v[148:151], v[204:207], a[48:51]
    v_mfma_f32_16x16x32_bf16 a[76:79], v[152:155], v[204:207], a[76:79]
    v_exp_f32 v17, v192
    v_mfma_f32_16x16x32_bf16 a[104:107], v[156:159], v[204:207], a[104:107]
    v_exp_f32 v18, v193
    v_mfma_f32_16x16x32_bf16 a[132:135], v[160:163], v[204:207], a[132:135]
    v_exp_f32 v19, v194
    v_mfma_f32_16x16x32_bf16 a[160:163], v[164:167], v[204:207], a[160:163]
    v_exp_f32 v20, v195
    v_mfma_f32_16x16x32_bf16 a[188:191], v[168:171], v[204:207], a[188:191]
    v_add_f32 v23, v17, v18
    v_cvt_pk_bf16_f32 v208, v17, v18
    v_mfma_f32_16x16x32_bf16 a[216:219], v[172:175], v[204:207], a[216:219]
    s_waitcnt lgkmcnt(0)
    s_add_u32 m0, s36, 0
    s_add_u32 s33, s37, 0
    buffer_load_dwordx4 v5, s[20:23], s33 offen offset:0 nt lds
    buffer_load_dwordx4 v6, s[20:23], s33 offen offset:1024 nt lds
    buffer_load_dwordx4 v5, s[20:23], s33 offen offset:2048 nt lds
    buffer_load_dwordx4 v6, s[20:23], s33 offen offset:3072 nt lds
    s_add_u32 m0, s36, 4096
    s_add_u32 s33, s37, 4096
    buffer_load_dwordx4 v5, s[20:23], s33 offen offset:0 nt lds
    buffer_load_dwordx4 v6, s[20:23], s33 offen offset:1024 nt lds
    buffer_load_dwordx4 v5, s[20:23], s33 offen offset:2048 nt lds
    buffer_load_dwordx4 v6, s[20:23], s33 offen offset:3072 nt lds
    s_add_u32 s37, s37, 8192
    s_add_u32 s36, s36, 8192
    s_cmp_eq_u32 s36, s44
    s_cselect_b32 s36, s32, s36
    v_mfma_f32_16x16x32_bf16 v[176:179], v[112:115], v[32:35], v[212:215]
    v_exp_f32 v17, v196
    v_mfma_f32_16x16x32_bf16 v[180:183], v[128:131], v[32:35], v[212:215]
    v_exp_f32 v18, v197
    v_mfma_f32_16x16x32_bf16 v[176:179], v[116:119], v[60:63], v[176:179]
    v_add_f32 v23, v23, v19
    v_add_f32 v23, v23, v20
    v_mfma_f32_16x16x32_bf16 v[180:183], v[132:135], v[60:63], v[180:183]
    v_cvt_pk_bf16_f32 v209, v19, v20
    v_mfma_f32_16x16x32_bf16 v[176:179], v[120:123], v[88:91], v[176:179]
    v_exp_f32 v19, v198
    v_mfma_f32_16x16x32_bf16 v[180:183], v[136:139], v[88:91], v[180:183]
    v_exp_f32 v20, v199
    v_mfma_f32_16x16x32_bf16 v[176:179], v[124:127], a[228:231], v[176:179]
    v_add_f32 v23, v23, v17
    v_add_f32 v23, v23, v18
    v_cvt_pk_bf16_f32 v210, v17, v18
    s_nop 0
    v_add_f32 v23, v23, v19
    v_add_f32 v23, v23, v20
    v_cvt_pk_bf16_f32 v211, v19, v20
    v_cmp_nge_f32 vcc, s38, v23
    s_or_b64 vcc, vcc, s[42:43]
    s_cbranch_vccnz L_rarea_6
L_rarea_6_ret:
    v_add_f32 v30, v30, v23
    v_mfma_f32_16x16x32_bf16 v[180:183], v[140:143], a[228:231], v[180:183]
    v_mfma_f32_16x16x32_bf16 a[24:27], v[144:147], v[208:211], a[24:27]
    v_mfma_f32_16x16x32_bf16 a[52:55], v[148:151], v[208:211], a[52:55]
    v_mfma_f32_16x16x32_bf16 a[80:83], v[152:155], v[208:211], a[80:83]
    v_mfma_f32_16x16x32_bf16 a[108:111], v[156:159], v[208:211], a[108:111]
    v_mfma_f32_16x16x32_bf16 a[136:139], v[160:163], v[208:211], a[136:139]
    v_mfma_f32_16x16x32_bf16 a[164:167], v[164:167], v[208:211], a[164:167]
    v_mfma_f32_16x16x32_bf16 a[192:195], v[168:171], v[208:211], a[192:195]
    v_mfma_f32_16x16x32_bf16 a[220:223], v[172:175], v[208:211], a[220:223]
    s_mov_b64 s[42:43], 0
    s_add_u32 s35, s35, 1
    s_cmp_lt_u32 s35, 16
    s_cbranch_scc1 L_Aa
    v_lshlrev_b32 v9, 4, v0
    v_add_u32 v14, 0, v9
    v_add_u32 v9, s32, v9
    s_mov_b32 s6, 0x2aaaaaab
    v_add_u32 v100, 0, v0
    v_mul_hi_u32 v101, v100, s6
    v_mul_u32_u24 v102, 6, v101
    v_sub_u32 v102, v100, v102
    v_mul_u32_u24 v101, 1152, v101
    v_lshl_add_u32 v10, v102, 4, v101
    v_add_u32 v100, 64, v0
    v_mul_hi_u32 v101, v100, s6
    v_mul_u32_u24 v102, 6, v101
    v_sub_u32 v102, v100, v102
    v_mul_u32_u24 v101, 1152, v101
    v_lshl_add_u32 v11, v102, 4, v101
    v_add_u32 v100, 128, v0
    v_mul_hi_u32 v101, v100, s6
    v_mul_u32_u24 v102, 6, v101
    v_sub_u32 v102, v100, v102
    v_mul_u32_u24 v101, 1152, v101
    v_lshl_add_u32 v12, v102, 4, v101
    v_lshrrev_b32 v100, 4, v0
    v_bfe_u32 v101, v0, 2, 2
    v_lshl_add_u32 v100, v100, 2, v101
    v_mul_u32_u24 v100, 96, v100
    v_and_b32 v101, 3, v0
    v_lshl_add_u32 v100, v101, 3, v100
    s_add_u32 s6, s32, 28672
    v_add_u32 v13, s6, v100
    s_mul_i32 s6, s54, 589824
    s_mul_i32 s7, s3, 288
    s_add_u32 s6, s6, s7
    s_sub_u32 s7, 589824, s7
    s_add_u32 s24, s80, s6
    s_addc_u32 s25, s81, 0
    s_and_b32 s25, s25, 0xffff
    s_mov_b32 s26, s7
    s_mov_b32 s27, 0x20000
    s_mov_b32 s47, 0
    s_waitcnt vmcnt(0)
    s_add_u32 m0, s32, 28672
    s_add_u32 s33, s47, 0
    buffer_load_dwordx4 v10, s[24:27], s33 offen lds
    s_add_u32 m0, s32, 29696
    s_nop 0
    buffer_load_dwordx4 v11, s[24:27], s33 offen lds
    s_add_u32 m0, s32, 30720
    s_nop 0
    buffer_load_dwordx4 v12, s[24:27], s33 offen lds
    s_add_u32 m0, s32, 31744
    s_add_u32 s33, s47, 96
    buffer_load_dwordx4 v10, s[24:27], s33 offen lds
    s_add_u32 m0, s32, 32768
    s_nop 0
    buffer_load_dwordx4 v11, s[24:27], s33 offen lds
    s_add_u32 m0, s32, 33792
    s_nop 0
    buffer_load_dwordx4 v12, s[24:27], s33 offen lds
    s_add_u32 m0, s32, 34816
    s_add_u32 s33, s47, 192
    buffer_load_dwordx4 v10, s[24:27], s33 offen lds
    s_add_u32 m0, s32, 35840
    s_nop 0
    buffer_load_dwordx4 v11, s[24:27], s33 offen lds
    s_add_u32 m0, s32, 36864
    s_nop 0
    buffer_load_dwordx4 v12, s[24:27], s33 offen lds
    s_add_u32 m0, s32, 37888
    s_add_u32 s33, s47, 36864
    buffer_load_dwordx4 v10, s[24:27], s33 offen lds
    s_add_u32 m0, s32, 38912
    s_nop 0
    buffer_load_dwordx4 v11, s[24:27], s33 offen lds
    s_add_u32 m0, s32, 39936
    s_nop 0
    buffer_load_dwordx4 v12, s[24:27], s33 offen lds
    v_mov_b32 v17, v24
    s_nop 1
    v_permlane32_swap_b32 v24, v17
    s_nop 1
    v_add_f32 v24, v24, v17
    v_mov_b32 v17, v24
    s_nop 1
    v_permlane16_swap_b32 v24, v17
    s_nop 1
    v_add_f32 v24, v24, v17
    v_rcp_f32 v24, v24
    v_accvgpr_read_b32 v32, a0
    v_accvgpr_read_b32 v36, a28
    v_accvgpr_read_b32 v33, a1
    v_accvgpr_read_b32 v37, a29
    v_accvgpr_read_b32 v34, a2
    v_accvgpr_read_b32 v38, a30
    v_accvgpr_read_b32 v35, a3
    v_accvgpr_read_b32 v39, a31
    v_mul_f32 v32, v32, v24
    v_mul_f32 v33, v33, v24
    v_mul_f32 v34, v34, v24
    v_mul_f32 v35, v35, v24
    v_mul_f32 v36, v36, v24
    v_mul_f32 v37, v37, v24
    v_mul_f32 v38, v38, v24
    v_mul_f32 v39, v39, v24
    v_cvt_pk_bf16_f32 v40, v32, v33
    v_cvt_pk_bf16_f32 v41, v34, v35
    v_cvt_pk_bf16_f32 v42, v36, v37
    v_cvt_pk_bf16_f32 v43, v38, v39
    ds_write_b128 v9, v[40:43] offset:0
    v_accvgpr_read_b32 v48, a56
    v_accvgpr_read_b32 v52, a84
    v_accvgpr_read_b32 v49, a57
    v_accvgpr_read_b32 v53, a85
    v_accvgpr_read_b32 v50, a58
    v_accvgpr_read_b32 v54, a86
    v_accvgpr_read_b32 v51, a59
    v_accvgpr_read_b32 v55, a87
    v_mul_f32 v48, v48, v24
    v_mul_f32 v49, v49, v24
    v_mul_f32 v50, v50, v24
    v_mul_f32 v51, v51, v24
    v_mul_f32 v52, v52, v24
    v_mul_f32 v53, v53, v24
    v_mul_f32 v54, v54, v24
    v_mul_f32 v55, v55, v24
    v_cvt_pk_bf16_f32 v56, v48, v49
    v_cvt_pk_bf16_f32 v57, v50, v51
    v_cvt_pk_bf16_f32 v58, v52, v53
    v_cvt_pk_bf16_f32 v59, v54, v55
    ds_write_b128 v9, v[56:59] offset:1024
    v_accvgpr_read_b32 v64, a112
    v_accvgpr_read_b32 v68, a140
    v_accvgpr_read_b32 v65, a113
    v_accvgpr_read_b32 v69, a141
    v_accvgpr_read_b32 v66, a114
    v_accvgpr_read_b32 v70, a142
    v_accvgpr_read_b32 v67, a115
    v_accvgpr_read_b32 v71, a143
    v_mul_f32 v64, v64, v24
    v_mul_f32 v65, v65, v24
    v_mul_f32 v66, v66, v24
    v_mul_f32 v67, v67, v24
    v_mul_f32 v68, v68, v24
    v_mul_f32 v69, v69, v24
    v_mul_f32 v70, v70, v24
    v_mul_f32 v71, v71, v24
    v_cvt_pk_bf16_f32 v72, v64, v65
    v_cvt_pk_bf16_f32 v73, v66, v67
    v_cvt_pk_bf16_f32 v74, v68, v69
    v_cvt_pk_bf16_f32 v75, v70, v71
    ds_write_b128 v9, v[72:75] offset:2048
    v_accvgpr_read_b32 v80, a168
    v_accvgpr_read_b32 v84, a196
    v_accvgpr_read_b32 v81, a169
    v_accvgpr_read_b32 v85, a197
    v_accvgpr_read_b32 v82, a170
    v_accvgpr_read_b32 v86, a198
    v_accvgpr_read_b32 v83, a171
    v_accvgpr_read_b32 v87, a199
    v_mul_f32 v80, v80, v24
    v_mul_f32 v81, v81, v24
    v_mul_f32 v82, v82, v24
    v_mul_f32 v83, v83, v24
    v_mul_f32 v84, v84, v24
    v_mul_f32 v85, v85, v24
    v_mul_f32 v86, v86, v24
    v_mul_f32 v87, v87, v24
    v_cvt_pk_bf16_f32 v88, v80, v81
    v_cvt_pk_bf16_f32 v89, v82, v83
    v_cvt_pk_bf16_f32 v90, v84, v85
    v_cvt_pk_bf16_f32 v91, v86, v87
    ds_write_b128 v9, v[88:91] offset:3072
    v_mov_b32 v17, v25
    s_nop 1
    v_permlane32_swap_b32 v25, v17
    s_nop 1
    v_add_f32 v25, v25, v17
    v_mov_b32 v17, v25
    s_nop 1
    v_permlane16_swap_b32 v25, v17
    s_nop 1
    v_add_f32 v25, v25, v17
    v_rcp_f32 v25, v25
    v_accvgpr_read_b32 v32, a4
    v_accvgpr_read_b32 v36, a32
    v_accvgpr_read_b32 v33, a5
    v_accvgpr_read_b32 v37, a33
    v_accvgpr_read_b32 v34, a6
    v_accvgpr_read_b32 v38, a34
    v_accvgpr_read_b32 v35, a7
    v_accvgpr_read_b32 v39, a35
    v_mul_f32 v32, v32, v25
    v_mul_f32 v33, v33, v25
    v_mul_f32 v34, v34, v25
    v_mul_f32 v35, v35, v25
    v_mul_f32 v36, v36, v25
    v_mul_f32 v37, v37, v25
    v_mul_f32 v38, v38, v25
    v_mul_f32 v39, v39, v25
    v_cvt_pk_bf16_f32 v40, v32, v33
    v_cvt_pk_bf16_f32 v41, v34, v35
    v_cvt_pk_bf16_f32 v42, v36, v37
    v_cvt_pk_bf16_f32 v43, v38, v39
    ds_write_b128 v9, v[40:43] offset:4096
    v_accvgpr_read_b32 v48, a60
    v_accvgpr_read_b32 v52, a88
    v_accvgpr_read_b32 v49, a61
    v_accvgpr_read_b32 v53, a89
    v_accvgpr_read_b32 v50, a62
    v_accvgpr_read_b32 v54, a90
    v_accvgpr_read_b32 v51, a63
    v_accvgpr_read_b32 v55, a91
    v_mul_f32 v48, v48, v25
    v_mul_f32 v49, v49, v25
    v_mul_f32 v50, v50, v25
    v_mul_f32 v51, v51, v25
    v_mul_f32 v52, v52, v25
    v_mul_f32 v53, v53, v25
    v_mul_f32 v54, v54, v25
    v_mul_f32 v55, v55, v25
    v_cvt_pk_bf16_f32 v56, v48, v49
    v_cvt_pk_bf16_f32 v57, v50, v51
    v_cvt_pk_bf16_f32 v58, v52, v53
    v_cvt_pk_bf16_f32 v59, v54, v55
    ds_write_b128 v9, v[56:59] offset:5120
    v_accvgpr_read_b32 v64, a116
    v_accvgpr_read_b32 v68, a144
    v_accvgpr_read_b32 v65, a117
    v_accvgpr_read_b32 v69, a145
    v_accvgpr_read_b32 v66, a118
    v_accvgpr_read_b32 v70, a146
    v_accvgpr_read_b32 v67, a119
    v_accvgpr_read_b32 v71, a147
    v_mul_f32 v64, v64, v25
    v_mul_f32 v65, v65, v25
    v_mul_f32 v66, v66, v25
    v_mul_f32 v67, v67, v25
    v_mul_f32 v68, v68, v25
    v_mul_f32 v69, v69, v25
    v_mul_f32 v70, v70, v25
    v_mul_f32 v71, v71, v25
    v_cvt_pk_bf16_f32 v72, v64, v65
    v_cvt_pk_bf16_f32 v73, v66, v67
    v_cvt_pk_bf16_f32 v74, v68, v69
    v_cvt_pk_bf16_f32 v75, v70, v71
    ds_write_b128 v9, v[72:75] offset:6144
    v_accvgpr_read_b32 v80, a172
    v_accvgpr_read_b32 v84, a200
    v_accvgpr_read_b32 v81, a173
    v_accvgpr_read_b32 v85, a201
    v_accvgpr_read_b32 v82, a174
    v_accvgpr_read_b32 v86, a202
    v_accvgpr_read_b32 v83, a175
    v_accvgpr_read_b32 v87, a203
    v_mul_f32 v80, v80, v25
    v_mul_f32 v81, v81, v25
    v_mul_f32 v82, v82, v25
    v_mul_f32 v83, v83, v25
    v_mul_f32 v84, v84, v25
    v_mul_f32 v85, v85, v25
    v_mul_f32 v86, v86, v25
    v_mul_f32 v87, v87, v25
    v_cvt_pk_bf16_f32 v88, v80, v81
    v_cvt_pk_bf16_f32 v89, v82, v83
    v_cvt_pk_bf16_f32 v90, v84, v85
    v_cvt_pk_bf16_f32 v91, v86, v87
    ds_write_b128 v9, v[88:91] offset:7168
    v_mov_b32 v17, v26
    s_nop 1
    v_permlane32_swap_b32 v26, v17
    s_nop 1
    v_add_f32 v26, v26, v17
    v_mov_b32 v17, v26
    s_nop 1
    v_permlane16_swap_b32 v26, v17
    s_nop 1
    v_add_f32 v26, v26, v17
    v_rcp_f32 v26, v26
    v_accvgpr_read_b32 v32, a8
    v_accvgpr_read_b32 v36, a36
    v_accvgpr_read_b32 v33, a9
    v_accvgpr_read_b32 v37, a37
    v_accvgpr_read_b32 v34, a10
    v_accvgpr_read_b32 v38, a38
    v_accvgpr_read_b32 v35, a11
    v_accvgpr_read_b32 v39, a39
    v_mul_f32 v32, v32, v26
    v_mul_f32 v33, v33, v26
    v_mul_f32 v34, v34, v26
    v_mul_f32 v35, v35, v26
    v_mul_f32 v36, v36, v26
    v_mul_f32 v37, v37, v26
    v_mul_f32 v38, v38, v26
    v_mul_f32 v39, v39, v26
    v_cvt_pk_bf16_f32 v40, v32, v33
    v_cvt_pk_bf16_f32 v41, v34, v35
    v_cvt_pk_bf16_f32 v42, v36, v37
    v_cvt_pk_bf16_f32 v43, v38, v39
    ds_write_b128 v9, v[40:43] offset:8192
    v_accvgpr_read_b32 v48, a64
    v_accvgpr_read_b32 v52, a92
    v_accvgpr_read_b32 v49, a65
    v_accvgpr_read_b32 v53, a93
    v_accvgpr_read_b32 v50, a66
    v_accvgpr_read_b32 v54, a94
    v_accvgpr_read_b32 v51, a67
    v_accvgpr_read_b32 v55, a95
    v_mul_f32 v48, v48, v26
    v_mul_f32 v49, v49, v26
    v_mul_f32 v50, v50, v26
    v_mul_f32 v51, v51, v26
    v_mul_f32 v52, v52, v26
    v_mul_f32 v53, v53, v26
    v_mul_f32 v54, v54, v26
    v_mul_f32 v55, v55, v26
    v_cvt_pk_bf16_f32 v56, v48, v49
    v_cvt_pk_bf16_f32 v57, v50, v51
    v_cvt_pk_bf16_f32 v58, v52, v53
    v_cvt_pk_bf16_f32 v59, v54, v55
    ds_write_b128 v9, v[56:59] offset:9216
    v_accvgpr_read_b32 v64, a120
    v_accvgpr_read_b32 v68, a148
    v_accvgpr_read_b32 v65, a121
    v_accvgpr_read_b32 v69, a149
    v_accvgpr_read_b32 v66, a122
    v_accvgpr_read_b32 v70, a150
    v_accvgpr_read_b32 v67, a123
    v_accvgpr_read_b32 v71, a151
    v_mul_f32 v64, v64, v26
    v_mul_f32 v65, v65, v26
    v_mul_f32 v66, v66, v26
    v_mul_f32 v67, v67, v26
    v_mul_f32 v68, v68, v26
    v_mul_f32 v69, v69, v26
    v_mul_f32 v70, v70, v26
    v_mul_f32 v71, v71, v26
    v_cvt_pk_bf16_f32 v72, v64, v65
    v_cvt_pk_bf16_f32 v73, v66, v67
    v_cvt_pk_bf16_f32 v74, v68, v69
    v_cvt_pk_bf16_f32 v75, v70, v71
    ds_write_b128 v9, v[72:75] offset:10240
    v_accvgpr_read_b32 v80, a176
    v_accvgpr_read_b32 v84, a204
    v_accvgpr_read_b32 v81, a177
    v_accvgpr_read_b32 v85, a205
    v_accvgpr_read_b32 v82, a178
    v_accvgpr_read_b32 v86, a206
    v_accvgpr_read_b32 v83, a179
    v_accvgpr_read_b32 v87, a207
    v_mul_f32 v80, v80, v26
    v_mul_f32 v81, v81, v26
    v_mul_f32 v82, v82, v26
    v_mul_f32 v83, v83, v26
    v_mul_f32 v84, v84, v26
    v_mul_f32 v85, v85, v26
    v_mul_f32 v86, v86, v26
    v_mul_f32 v87, v87, v26
    v_cvt_pk_bf16_f32 v88, v80, v81
    v_cvt_pk_bf16_f32 v89, v82, v83
    v_cvt_pk_bf16_f32 v90, v84, v85
    v_cvt_pk_bf16_f32 v91, v86, v87
    ds_write_b128 v9, v[88:91] offset:11264
    v_mov_b32 v17, v27
    s_nop 1
    v_permlane32_swap_b32 v27, v17
    s_nop 1
    v_add_f32 v27, v27, v17
    v_mov_b32 v17, v27
    s_nop 1
    v_permlane16_swap_b32 v27, v17
    s_nop 1
    v_add_f32 v27, v27, v17
    v_rcp_f32 v27, v27
    v_accvgpr_read_b32 v32, a12
    v_accvgpr_read_b32 v36, a40
    v_accvgpr_read_b32 v33, a13
    v_accvgpr_read_b32 v37, a41
    v_accvgpr_read_b32 v34, a14
    v_accvgpr_read_b32 v38, a42
    v_accvgpr_read_b32 v35, a15
    v_accvgpr_read_b32 v39, a43
    v_mul_f32 v32, v32, v27
    v_mul_f32 v33, v33, v27
    v_mul_f32 v34, v34, v27
    v_mul_f32 v35, v35, v27
    v_mul_f32 v36, v36, v27
    v_mul_f32 v37, v37, v27
    v_mul_f32 v38, v38, v27
    v_mul_f32 v39, v39, v27
    v_cvt_pk_bf16_f32 v40, v32, v33
    v_cvt_pk_bf16_f32 v41, v34, v35
    v_cvt_pk_bf16_f32 v42, v36, v37
    v_cvt_pk_bf16_f32 v43, v38, v39
    ds_write_b128 v9, v[40:43] offset:12288
    v_accvgpr_read_b32 v48, a68
    v_accvgpr_read_b32 v52, a96
    v_accvgpr_read_b32 v49, a69
    v_accvgpr_read_b32 v53, a97
    v_accvgpr_read_b32 v50, a70
    v_accvgpr_read_b32 v54, a98
    v_accvgpr_read_b32 v51, a71
    v_accvgpr_read_b32 v55, a99
    v_mul_f32 v48, v48, v27
    v_mul_f32 v49, v49, v27
    v_mul_f32 v50, v50, v27
    v_mul_f32 v51, v51, v27
    v_mul_f32 v52, v52, v27
    v_mul_f32 v53, v53, v27
    v_mul_f32 v54, v54, v27
    v_mul_f32 v55, v55, v27
    v_cvt_pk_bf16_f32 v56, v48, v49
    v_cvt_pk_bf16_f32 v57, v50, v51
    v_cvt_pk_bf16_f32 v58, v52, v53
    v_cvt_pk_bf16_f32 v59, v54, v55
    ds_write_b128 v9, v[56:59] offset:13312
    v_accvgpr_read_b32 v64, a124
    v_accvgpr_read_b32 v68, a152
    v_accvgpr_read_b32 v65, a125
    v_accvgpr_read_b32 v69, a153
    v_accvgpr_read_b32 v66, a126
    v_accvgpr_read_b32 v70, a154
    v_accvgpr_read_b32 v67, a127
    v_accvgpr_read_b32 v71, a155
    v_mul_f32 v64, v64, v27
    v_mul_f32 v65, v65, v27
    v_mul_f32 v66, v66, v27
    v_mul_f32 v67, v67, v27
    v_mul_f32 v68, v68, v27
    v_mul_f32 v69, v69, v27
    v_mul_f32 v70, v70, v27
    v_mul_f32 v71, v71, v27
    v_cvt_pk_bf16_f32 v72, v64, v65
    v_cvt_pk_bf16_f32 v73, v66, v67
    v_cvt_pk_bf16_f32 v74, v68, v69
    v_cvt_pk_bf16_f32 v75, v70, v71
    ds_write_b128 v9, v[72:75] offset:14336
    v_accvgpr_read_b32 v80, a180
    v_accvgpr_read_b32 v84, a208
    v_accvgpr_read_b32 v81, a181
    v_accvgpr_read_b32 v85, a209
    v_accvgpr_read_b32 v82, a182
    v_accvgpr_read_b32 v86, a210
    v_accvgpr_read_b32 v83, a183
    v_accvgpr_read_b32 v87, a211
    v_mul_f32 v80, v80, v27
    v_mul_f32 v81, v81, v27
    v_mul_f32 v82, v82, v27
    v_mul_f32 v83, v83, v27
    v_mul_f32 v84, v84, v27
    v_mul_f32 v85, v85, v27
    v_mul_f32 v86, v86, v27
    v_mul_f32 v87, v87, v27
    v_cvt_pk_bf16_f32 v88, v80, v81
    v_cvt_pk_bf16_f32 v89, v82, v83
    v_cvt_pk_bf16_f32 v90, v84, v85
    v_cvt_pk_bf16_f32 v91, v86, v87
    ds_write_b128 v9, v[88:91] offset:15360
    v_mov_b32 v17, v28
    s_nop 1
    v_permlane32_swap_b32 v28, v17
    s_nop 1
    v_add_f32 v28, v28, v17
    v_mov_b32 v17, v28
    s_nop 1
    v_permlane16_swap_b32 v28, v17
    s_nop 1
    v_add_f32 v28, v28, v17
    v_rcp_f32 v28, v28
    v_accvgpr_read_b32 v32, a16
    v_accvgpr_read_b32 v36, a44
    v_accvgpr_read_b32 v33, a17
    v_accvgpr_read_b32 v37, a45
    v_accvgpr_read_b32 v34, a18
    v_accvgpr_read_b32 v38, a46
    v_accvgpr_read_b32 v35, a19
    v_accvgpr_read_b32 v39, a47
    v_mul_f32 v32, v32, v28
    v_mul_f32 v33, v33, v28
    v_mul_f32 v34, v34, v28
    v_mul_f32 v35, v35, v28
    v_mul_f32 v36, v36, v28
    v_mul_f32 v37, v37, v28
    v_mul_f32 v38, v38, v28
    v_mul_f32 v39, v39, v28
    v_cvt_pk_bf16_f32 v40, v32, v33
    v_cvt_pk_bf16_f32 v41, v34, v35
    v_cvt_pk_bf16_f32 v42, v36, v37
    v_cvt_pk_bf16_f32 v43, v38, v39
    ds_write_b128 v9, v[40:43] offset:16384
    v_accvgpr_read_b32 v48, a72
    v_accvgpr_read_b32 v52, a100
    v_accvgpr_read_b32 v49, a73
    v_accvgpr_read_b32 v53, a101
    v_accvgpr_read_b32 v50, a74
    v_accvgpr_read_b32 v54, a102
    v_accvgpr_read_b32 v51, a75
    v_accvgpr_read_b32 v55, a103
    v_mul_f32 v48, v48, v28
    v_mul_f32 v49, v49, v28
    v_mul_f32 v50, v50, v28
    v_mul_f32 v51, v51, v28
    v_mul_f32 v52, v52, v28
    v_mul_f32 v53, v53, v28
    v_mul_f32 v54, v54, v28
    v_mul_f32 v55, v55, v28
    v_cvt_pk_bf16_f32 v56, v48, v49
    v_cvt_pk_bf16_f32 v57, v50, v51
    v_cvt_pk_bf16_f32 v58, v52, v53
    v_cvt_pk_bf16_f32 v59, v54, v55
    ds_write_b128 v9, v[56:59] offset:17408
    v_accvgpr_read_b32 v64, a128
    v_accvgpr_read_b32 v68, a156
    v_accvgpr_read_b32 v65, a129
    v_accvgpr_read_b32 v69, a157
    v_accvgpr_read_b32 v66, a130
    v_accvgpr_read_b32 v70, a158
    v_accvgpr_read_b32 v67, a131
    v_accvgpr_read_b32 v71, a159
    v_mul_f32 v64, v64, v28
    v_mul_f32 v65, v65, v28
    v_mul_f32 v66, v66, v28
    v_mul_f32 v67, v67, v28
    v_mul_f32 v68, v68, v28
    v_mul_f32 v69, v69, v28
    v_mul_f32 v70, v70, v28
    v_mul_f32 v71, v71, v28
    v_cvt_pk_bf16_f32 v72, v64, v65
    v_cvt_pk_bf16_f32 v73, v66, v67
    v_cvt_pk_bf16_f32 v74, v68, v69
    v_cvt_pk_bf16_f32 v75, v70, v71
    ds_write_b128 v9, v[72:75] offset:18432
    v_accvgpr_read_b32 v80, a184
    v_accvgpr_read_b32 v84, a212
    v_accvgpr_read_b32 v81, a185
    v_accvgpr_read_b32 v85, a213
    v_accvgpr_read_b32 v82, a186
    v_accvgpr_read_b32 v86, a214
    v_accvgpr_read_b32 v83, a187
    v_accvgpr_read_b32 v87, a215
    v_mul_f32 v80, v80, v28
    v_mul_f32 v81, v81, v28
    v_mul_f32 v82, v82, v28
    v_mul_f32 v83, v83, v28
    v_mul_f32 v84, v84, v28
    v_mul_f32 v85, v85, v28
    v_mul_f32 v86, v86, v28
    v_mul_f32 v87, v87, v28
    v_cvt_pk_bf16_f32 v88, v80, v81
    v_cvt_pk_bf16_f32 v89, v82, v83
    v_cvt_pk_bf16_f32 v90, v84, v85
    v_cvt_pk_bf16_f32 v91, v86, v87
    ds_write_b128 v9, v[88:91] offset:19456
    v_mov_b32 v17, v29
    s_nop 1
    v_permlane32_swap_b32 v29, v17
    s_nop 1
    v_add_f32 v29, v29, v17
    v_mov_b32 v17, v29
    s_nop 1
    v_permlane16_swap_b32 v29, v17
    s_nop 1
    v_add_f32 v29, v29, v17
    v_rcp_f32 v29, v29
    v_accvgpr_read_b32 v32, a20
    v_accvgpr_read_b32 v36, a48
    v_accvgpr_read_b32 v33, a21
    v_accvgpr_read_b32 v37, a49
    v_accvgpr_read_b32 v34, a22
    v_accvgpr_read_b32 v38, a50
    v_accvgpr_read_b32 v35, a23
    v_accvgpr_read_b32 v39, a51
    v_mul_f32 v32, v32, v29
    v_mul_f32 v33, v33, v29
    v_mul_f32 v34, v34, v29
    v_mul_f32 v35, v35, v29
    v_mul_f32 v36, v36, v29
    v_mul_f32 v37, v37, v29
    v_mul_f32 v38, v38, v29
    v_mul_f32 v39, v39, v29
    v_cvt_pk_bf16_f32 v40, v32, v33
    v_cvt_pk_bf16_f32 v41, v34, v35
    v_cvt_pk_bf16_f32 v42, v36, v37
    v_cvt_pk_bf16_f32 v43, v38, v39
    ds_write_b128 v9, v[40:43] offset:20480
    v_accvgpr_read_b32 v48, a76
    v_accvgpr_read_b32 v52, a104
    v_accvgpr_read_b32 v49, a77
    v_accvgpr_read_b32 v53, a105
    v_accvgpr_read_b32 v50, a78
    v_accvgpr_read_b32 v54, a106
    v_accvgpr_read_b32 v51, a79
    v_accvgpr_read_b32 v55, a107
    v_mul_f32 v48, v48, v29
    v_mul_f32 v49, v49, v29
    v_mul_f32 v50, v50, v29
    v_mul_f32 v51, v51, v29
    v_mul_f32 v52, v52, v29
    v_mul_f32 v53, v53, v29
    v_mul_f32 v54, v54, v29
    v_mul_f32 v55, v55, v29
    v_cvt_pk_bf16_f32 v56, v48, v49
    v_cvt_pk_bf16_f32 v57, v50, v51
    v_cvt_pk_bf16_f32 v58, v52, v53
    v_cvt_pk_bf16_f32 v59, v54, v55
    ds_write_b128 v9, v[56:59] offset:21504
    v_accvgpr_read_b32 v64, a132
    v_accvgpr_read_b32 v68, a160
    v_accvgpr_read_b32 v65, a133
    v_accvgpr_read_b32 v69, a161
    v_accvgpr_read_b32 v66, a134
    v_accvgpr_read_b32 v70, a162
    v_accvgpr_read_b32 v67, a135
    v_accvgpr_read_b32 v71, a163
    v_mul_f32 v64, v64, v29
    v_mul_f32 v65, v65, v29
    v_mul_f32 v66, v66, v29
    v_mul_f32 v67, v67, v29
    v_mul_f32 v68, v68, v29
    v_mul_f32 v69, v69, v29
    v_mul_f32 v70, v70, v29
    v_mul_f32 v71, v71, v29
    v_cvt_pk_bf16_f32 v72, v64, v65
    v_cvt_pk_bf16_f32 v73, v66, v67
    v_cvt_pk_bf16_f32 v74, v68, v69
    v_cvt_pk_bf16_f32 v75, v70, v71
    ds_write_b128 v9, v[72:75] offset:22528
    v_accvgpr_read_b32 v80, a188
    v_accvgpr_read_b32 v84, a216
    v_accvgpr_read_b32 v81, a189
    v_accvgpr_read_b32 v85, a217
    v_accvgpr_read_b32 v82, a190
    v_accvgpr_read_b32 v86, a218
    v_accvgpr_read_b32 v83, a191
    v_accvgpr_read_b32 v87, a219
    v_mul_f32 v80, v80, v29
    v_mul_f32 v81, v81, v29
    v_mul_f32 v82, v82, v29
    v_mul_f32 v83, v83, v29
    v_mul_f32 v84, v84, v29
    v_mul_f32 v85, v85, v29
    v_mul_f32 v86, v86, v29
    v_mul_f32 v87, v87, v29
    v_cvt_pk_bf16_f32 v88, v80, v81
    v_cvt_pk_bf16_f32 v89, v82, v83
    v_cvt_pk_bf16_f32 v90, v84, v85
    v_cvt_pk_bf16_f32 v91, v86, v87
    ds_write_b128 v9, v[88:91] offset:23552
    v_mov_b32 v17, v30
    s_nop 1
    v_permlane32_swap_b32 v30, v17
    s_nop 1
    v_add_f32 v30, v30, v17
    v_mov_b32 v17, v30
    s_nop 1
    v_permlane16_swap_b32 v30, v17
    s_nop 1
    v_add_f32 v30, v30, v17
    v_rcp_f32 v30, v30
    v_accvgpr_read_b32 v32, a24
    v_accvgpr_read_b32 v36, a52
    v_accvgpr_read_b32 v33, a25
    v_accvgpr_read_b32 v37, a53
    v_accvgpr_read_b32 v34, a26
    v_accvgpr_read_b32 v38, a54
    v_accvgpr_read_b32 v35, a27
    v_accvgpr_read_b32 v39, a55
    v_mul_f32 v32, v32, v30
    v_mul_f32 v33, v33, v30
    v_mul_f32 v34, v34, v30
    v_mul_f32 v35, v35, v30
    v_mul_f32 v36, v36, v30
    v_mul_f32 v37, v37, v30
    v_mul_f32 v38, v38, v30
    v_mul_f32 v39, v39, v30
    v_cvt_pk_bf16_f32 v40, v32, v33
    v_cvt_pk_bf16_f32 v41, v34, v35
    v_cvt_pk_bf16_f32 v42, v36, v37
    v_cvt_pk_bf16_f32 v43, v38, v39
    ds_write_b128 v9, v[40:43] offset:24576
    v_accvgpr_read_b32 v48, a80
    v_accvgpr_read_b32 v52, a108
    v_accvgpr_read_b32 v49, a81
    v_accvgpr_read_b32 v53, a109
    v_accvgpr_read_b32 v50, a82
    v_accvgpr_read_b32 v54, a110
    v_accvgpr_read_b32 v51, a83
    v_accvgpr_read_b32 v55, a111
    v_mul_f32 v48, v48, v30
    v_mul_f32 v49, v49, v30
    v_mul_f32 v50, v50, v30
    v_mul_f32 v51, v51, v30
    v_mul_f32 v52, v52, v30
    v_mul_f32 v53, v53, v30
    v_mul_f32 v54, v54, v30
    v_mul_f32 v55, v55, v30
    v_cvt_pk_bf16_f32 v56, v48, v49
    v_cvt_pk_bf16_f32 v57, v50, v51
    v_cvt_pk_bf16_f32 v58, v52, v53
    v_cvt_pk_bf16_f32 v59, v54, v55
    ds_write_b128 v9, v[56:59] offset:25600
    v_accvgpr_read_b32 v64, a136
    v_accvgpr_read_b32 v68, a164
    v_accvgpr_read_b32 v65, a137
    v_accvgpr_read_b32 v69, a165
    v_accvgpr_read_b32 v66, a138
    v_accvgpr_read_b32 v70, a166
    v_accvgpr_read_b32 v67, a139
    v_accvgpr_read_b32 v71, a167
    v_mul_f32 v64, v64, v30
    v_mul_f32 v65, v65, v30
    v_mul_f32 v66, v66, v30
    v_mul_f32 v67, v67, v30
    v_mul_f32 v68, v68, v30
    v_mul_f32 v69, v69, v30
    v_mul_f32 v70, v70, v30
    v_mul_f32 v71, v71, v30
    v_cvt_pk_bf16_f32 v72, v64, v65
    v_cvt_pk_bf16_f32 v73, v66, v67
    v_cvt_pk_bf16_f32 v74, v68, v69
    v_cvt_pk_bf16_f32 v75, v70, v71
    ds_write_b128 v9, v[72:75] offset:26624
    v_accvgpr_read_b32 v80, a192
    v_accvgpr_read_b32 v84, a220
    v_accvgpr_read_b32 v81, a193
    v_accvgpr_read_b32 v85, a221
    v_accvgpr_read_b32 v82, a194
    v_accvgpr_read_b32 v86, a222
    v_accvgpr_read_b32 v83, a195
    v_accvgpr_read_b32 v87, a223
    v_mul_f32 v80, v80, v30
    v_mul_f32 v81, v81, v30
    v_mul_f32 v82, v82, v30
    v_mul_f32 v83, v83, v30
    v_mul_f32 v84, v84, v30
    v_mul_f32 v85, v85, v30
    v_mul_f32 v86, v86, v30
    v_mul_f32 v87, v87, v30
    v_cvt_pk_bf16_f32 v88, v80, v81
    v_cvt_pk_bf16_f32 v89, v82, v83
    v_cvt_pk_bf16_f32 v90, v84, v85
    v_cvt_pk_bf16_f32 v91, v86, v87
    ds_write_b128 v9, v[88:91] offset:27648
    s_lshl_b32 s6, s50, 4
    s_add_u32 s6, s6, s52
    s_lshl_b32 s6, s6, 3
    s_add_u32 s6, s6, s54
    s_lshl_b32 s6, s6, 2
    s_add_u32 s6, s6, s3
    s_lshl_b32 s6, s6, 15
    s_add_u32 s28, s82, s6
    s_addc_u32 s29, s83, 0
    s_and_b32 s29, s29, 0xffff
    s_mov_b32 s30, 32768
    s_mov_b32 s31, 0x20000
    s_waitcnt lgkmcnt(0)
    s_barrier
    v_add_u32 v15, 40960, v14
    ds_read_b128 v[32:35], v14 offset:0
    ds_read_b128 v[36:39], v14 offset:4096
    ds_read_b128 v[40:43], v14 offset:8192
    ds_read_b128 v[44:47], v14 offset:12288
    ds_read_b128 v[48:51], v14 offset:16384
    ds_read_b128 v[52:55], v14 offset:20480
    ds_read_b128 v[56:59], v14 offset:24576
    s_waitcnt vmcnt(9)
    ds_read_b64_tr_b16 v[88:89], v13 offset:0
    ds_read_b64_tr_b16 v[90:91], v13 offset:1536
    ds_read_b64_tr_b16 v[92:93], v13 offset:32
    ds_read_b64_tr_b16 v[94:95], v13 offset:1568
    s_waitcnt lgkmcnt(0)
    v_mfma_f32_16x16x32_bf16 a[0:3], v[88:91], v[32:35], 0
    v_mfma_f32_16x16x32_bf16 a[4:7], v[88:91], v[36:39], 0
    ds_read_b64_tr_b16 v[96:97], v13 offset:64
    v_mfma_f32_16x16x32_bf16 a[8:11], v[88:91], v[40:43], 0
    ds_read_b64_tr_b16 v[98:99], v13 offset:1600
    v_mfma_f32_16x16x32_bf16 a[12:15], v[88:91], v[44:47], 0
    v_mfma_f32_16x16x32_bf16 a[16:19], v[88:91], v[48:51], 0
    v_mfma_f32_16x16x32_bf16 a[20:23], v[88:91], v[52:55], 0
    v_mfma_f32_16x16x32_bf16 a[24:27], v[88:91], v[56:59], 0
    s_waitcnt lgkmcnt(2)
    v_mfma_f32_16x16x32_bf16 a[28:31], v[92:95], v[32:35], 0
    s_waitcnt vmcnt(6)
    v_mfma_f32_16x16x32_bf16 a[32:35], v[92:95], v[36:39], 0
    ds_read_b64_tr_b16 v[100:101], v13 offset:3072
    v_mfma_f32_16x16x32_bf16 a[36:39], v[92:95], v[40:43], 0
    ds_read_b64_tr_b16 v[102:103], v13 offset:4608
    v_mfma_f32_16x16x32_bf16 a[40:43], v[92:95], v[44:47], 0
    v_mfma_f32_16x16x32_bf16 a[44:47], v[92:95], v[48:51], 0
    v_mfma_f32_16x16x32_bf16 a[48:51], v[92:95], v[52:55], 0
    v_mfma_f32_16x16x32_bf16 a[52:55], v[92:95], v[56:59], 0
    s_waitcnt lgkmcnt(2)
    v_mfma_f32_16x16x32_bf16 a[56:59], v[96:99], v[32:35], 0
    v_mfma_f32_16x16x32_bf16 a[60:63], v[96:99], v[36:39], 0
    ds_read_b64_tr_b16 v[88:89], v13 offset:3104
    v_mfma_f32_16x16x32_bf16 a[64:67], v[96:99], v[40:43], 0
    ds_read_b64_tr_b16 v[90:91], v13 offset:4640
    v_mfma_f32_16x16x32_bf16 a[68:71], v[96:99], v[44:47], 0
    s_add_u32 m0, s32, 28672
    s_add_u32 s33, s47, 36960
    buffer_load_dwordx4 v10, s[24:27], s33 offen lds
    v_mfma_f32_16x16x32_bf16 a[72:75], v[96:99], v[48:51], 0
    s_add_u32 m0, s32, 29696
    s_nop 0
    buffer_load_dwordx4 v11, s[24:27], s33 offen lds
    v_mfma_f32_16x16x32_bf16 a[76:79], v[96:99], v[52:55], 0
    s_add_u32 m0, s32, 30720
    s_nop 0
    buffer_load_dwordx4 v12, s[24:27], s33 offen lds
    v_mfma_f32_16x16x32_bf16 a[80:83], v[96:99], v[56:59], 0
    s_waitcnt lgkmcnt(2)
    v_mfma_f32_16x16x32_bf16 a[84:87], v[100:103], v[32:35], 0
    v_mfma_f32_16x16x32_bf16 a[88:91], v[100:103], v[36:39], 0
    ds_read_b64_tr_b16 v[92:93], v13 offset:3136
    v_mfma_f32_16x16x32_bf16 a[92:95], v[100:103], v[40:43], 0
    ds_read_b64_tr_b16 v[94:95], v13 offset:4672
    v_mfma_f32_16x16x32_bf16 a[96:99], v[100:103], v[44:47], 0
    v_mfma_f32_16x16x32_bf16 a[100:103], v[100:103], v[48:51], 0
    v_mfma_f32_16x16x32_bf16 a[104:107], v[100:103], v[52:55], 0
    v_mfma_f32_16x16x32_bf16 a[108:111], v[100:103], v[56:59], 0
    s_waitcnt lgkmcnt(2)
    v_mfma_f32_16x16x32_bf16 a[112:115], v[88:91], v[32:35], 0
    s_waitcnt vmcnt(6)
    v_mfma_f32_16x16x32_bf16 a[116:119], v[88:91], v[36:39], 0
    ds_read_b64_tr_b16 v[96:97], v13 offset:6144
    v_mfma_f32_16x16x32_bf16 a[120:123], v[88:91], v[40:43], 0
    ds_read_b64_tr_b16 v[98:99], v13 offset:7680
    v_mfma_f32_16x16x32_bf16 a[124:127], v[88:91], v[44:47], 0
    ds_read_b128 v[60:63], v14 offset:1024
    v_mfma_f32_16x16x32_bf16 a[128:131], v[88:91], v[48:51], 0
    ds_read_b128 v[64:67], v14 offset:5120
    v_mfma_f32_16x16x32_bf16 a[132:135], v[88:91], v[52:55], 0
    ds_read_b128 v[68:71], v14 offset:9216
    v_mfma_f32_16x16x32_bf16 a[136:139], v[88:91], v[56:59], 0
    s_waitcnt lgkmcnt(5)
    ds_read_b128 v[72:75], v14 offset:13312
    v_mfma_f32_16x16x32_bf16 a[140:143], v[92:95], v[32:35], 0
    v_mfma_f32_16x16x32_bf16 a[144:147], v[92:95], v[36:39], 0
    ds_read_b64_tr_b16 v[100:101], v13 offset:6176
    v_mfma_f32_16x16x32_bf16 a[148:151], v[92:95], v[40:43], 0
    ds_read_b64_tr_b16 v[102:103], v13 offset:7712
    v_mfma_f32_16x16x32_bf16 a[152:155], v[92:95], v[44:47], 0
    ds_read_b128 v[76:79], v14 offset:17408
    s_add_u32 m0, s32, 31744
    s_add_u32 s33, s47, 37056
    buffer_load_dwordx4 v10, s[24:27], s33 offen lds
    v_mfma_f32_16x16x32_bf16 a[156:159], v[92:95], v[48:51], 0
    ds_read_b128 v[80:83], v14 offset:21504
    s_add_u32 m0, s32, 32768
    s_nop 0
    buffer_load_dwordx4 v11, s[24:27], s33 offen lds
    v_mfma_f32_16x16x32_bf16 a[160:163], v[92:95], v[52:55], 0
    ds_read_b128 v[84:87], v14 offset:25600
    s_add_u32 m0, s32, 33792
    s_nop 0
    buffer_load_dwordx4 v12, s[24:27], s33 offen lds
    v_mfma_f32_16x16x32_bf16 a[164:167], v[92:95], v[56:59], 0
    s_waitcnt lgkmcnt(9)
    v_mfma_f32_16x16x32_bf16 a[168:171], v[96:99], v[32:35], 0
    v_mfma_f32_16x16x32_bf16 a[172:175], v[96:99], v[36:39], 0
    ds_read_b64_tr_b16 v[88:89], v13 offset:6208
    v_mfma_f32_16x16x32_bf16 a[176:179], v[96:99], v[40:43], 0
    ds_read_b64_tr_b16 v[90:91], v13 offset:7744
    v_mfma_f32_16x16x32_bf16 a[180:183], v[96:99], v[44:47], 0
    v_mfma_f32_16x16x32_bf16 a[184:187], v[96:99], v[48:51], 0
    v_mfma_f32_16x16x32_bf16 a[188:191], v[96:99], v[52:55], 0
    v_mfma_f32_16x16x32_bf16 a[192:195], v[96:99], v[56:59], 0
    s_waitcnt lgkmcnt(5)
    v_mfma_f32_16x16x32_bf16 a[196:199], v[100:103], v[32:35], 0
    s_waitcnt vmcnt(6)
    v_mfma_f32_16x16x32_bf16 a[200:203], v[100:103], v[36:39], 0
    ds_read_b64_tr_b16 v[92:93], v13 offset:9216
    v_mfma_f32_16x16x32_bf16 a[204:207], v[100:103], v[40:43], 0
    ds_read_b64_tr_b16 v[94:95], v13 offset:10752
    v_mfma_f32_16x16x32_bf16 a[208:211], v[100:103], v[44:47], 0
    v_mfma_f32_16x16x32_bf16 a[212:215], v[100:103], v[48:51], 0
    v_mfma_f32_16x16x32_bf16 a[216:219], v[100:103], v[52:55], 0
    v_mfma_f32_16x16x32_bf16 a[220:223], v[100:103], v[56:59], 0
    s_waitcnt lgkmcnt(2)
    v_mfma_f32_16x16x32_bf16 a[224:227], v[88:91], v[32:35], 0
    v_mfma_f32_16x16x32_bf16 a[228:231], v[88:91], v[36:39], 0
    ds_read_b64_tr_b16 v[96:97], v13 offset:9248
    v_mfma_f32_16x16x32_bf16 a[232:235], v[88:91], v[40:43], 0
    ds_read_b64_tr_b16 v[98:99], v13 offset:10784
    v_mfma_f32_16x16x32_bf16 a[236:239], v[88:91], v[44:47], 0
    s_add_u32 m0, s32, 34816
    s_add_u32 s33, s47, 73728
    buffer_load_dwordx4 v10, s[24:27], s33 offen lds
    v_mfma_f32_16x16x32_bf16 a[240:243], v[88:91], v[48:51], 0
    s_add_u32 m0, s32, 35840
    s_nop 0
    buffer_load_dwordx4 v11, s[24:27], s33 offen lds
    v_mfma_f32_16x16x32_bf16 a[244:247], v[88:91], v[52:55], 0
    s_add_u32 m0, s32, 36864
    s_nop 0
    buffer_load_dwordx4 v12, s[24:27], s33 offen lds
    v_mfma_f32_16x16x32_bf16 a[248:251], v[88:91], v[56:59], 0
    s_waitcnt lgkmcnt(2)
    v_mfma_f32_16x16x32_bf16 a[0:3], v[92:95], v[60:63], a[0:3]
    v_mfma_f32_16x16x32_bf16 a[4:7], v[92:95], v[64:67], a[4:7]
    ds_read_b64_tr_b16 v[100:101], v13 offset:9280
    v_mfma_f32_16x16x32_bf16 a[8:11], v[92:95], v[68:71], a[8:11]
    ds_read_b64_tr_b16 v[102:103], v13 offset:10816
    v_mfma_f32_16x16x32_bf16 a[12:15], v[92:95], v[72:75], a[12:15]
    v_mfma_f32_16x16x32_bf16 a[16:19], v[92:95], v[76:79], a[16:19]
    v_mfma_f32_16x16x32_bf16 a[20:23], v[92:95], v[80:83], a[20:23]
    v_mfma_f32_16x16x32_bf16 a[24:27], v[92:95], v[84:87], a[24:27]
    s_waitcnt lgkmcnt(2)
    v_mfma_f32_16x16x32_bf16 a[28:31], v[96:99], v[60:63], a[28:31]
    s_waitcnt vmcnt(6)
    v_mfma_f32_16x16x32_bf16 a[32:35], v[96:99], v[64:67], a[32:35]
    ds_read_b64_tr_b16 v[88:89], v13 offset:0
    v_mfma_f32_16x16x32_bf16 a[36:39], v[96:99], v[68:71], a[36:39]
    ds_read_b64_tr_b16 v[90:91], v13 offset:1536
    v_mfma_f32_16x16x32_bf16 a[40:43], v[96:99], v[72:75], a[40:43]
    v_mfma_f32_16x16x32_bf16 a[44:47], v[96:99], v[76:79], a[44:47]
    v_mfma_f32_16x16x32_bf16 a[48:51], v[96:99], v[80:83], a[48:51]
    v_mfma_f32_16x16x32_bf16 a[52:55], v[96:99], v[84:87], a[52:55]
    s_waitcnt lgkmcnt(2)
    v_mfma_f32_16x16x32_bf16 a[56:59], v[100:103], v[60:63], a[56:59]
    v_mfma_f32_16x16x32_bf16 a[60:63], v[100:103], v[64:67], a[60:63]
    ds_read_b64_tr_b16 v[92:93], v13 offset:32
    v_mfma_f32_16x16x32_bf16 a[64:67], v[100:103], v[68:71], a[64:67]
    ds_read_b64_tr_b16 v[94:95], v13 offset:1568
    v_mfma_f32_16x16x32_bf16 a[68:71], v[100:103], v[72:75], a[68:71]
    s_add_u32 m0, s32, 37888
    s_add_u32 s33, s47, 73824
    buffer_load_dwordx4 v10, s[24:27], s33 offen lds
    v_mfma_f32_16x16x32_bf16 a[72:75], v[100:103], v[76:79], a[72:75]
    s_add_u32 m0, s32, 38912
    s_nop 0
    buffer_load_dwordx4 v11, s[24:27], s33 offen lds
    v_mfma_f32_16x16x32_bf16 a[76:79], v[100:103], v[80:83], a[76:79]
    s_add_u32 m0, s32, 39936
    s_nop 0
    buffer_load_dwordx4 v12, s[24:27], s33 offen lds
    v_mfma_f32_16x16x32_bf16 a[80:83], v[100:103], v[84:87], a[80:83]
    s_waitcnt lgkmcnt(2)
    v_mfma_f32_16x16x32_bf16 a[84:87], v[88:91], v[60:63], a[84:87]
    v_mfma_f32_16x16x32_bf16 a[88:91], v[88:91], v[64:67], a[88:91]
    ds_read_b64_tr_b16 v[96:97], v13 offset:64
    v_mfma_f32_16x16x32_bf16 a[92:95], v[88:91], v[68:71], a[92:95]
    ds_read_b64_tr_b16 v[98:99], v13 offset:1600
    v_mfma_f32_16x16x32_bf16 a[96:99], v[88:91], v[72:75], a[96:99]
    v_mfma_f32_16x16x32_bf16 a[100:103], v[88:91], v[76:79], a[100:103]
    v_mfma_f32_16x16x32_bf16 a[104:107], v[88:91], v[80:83], a[104:107]
    v_mfma_f32_16x16x32_bf16 a[108:111], v[88:91], v[84:87], a[108:111]
    s_waitcnt lgkmcnt(2)
    v_mfma_f32_16x16x32_bf16 a[112:115], v[92:95], v[60:63], a[112:115]
    s_waitcnt vmcnt(6)
    v_mfma_f32_16x16x32_bf16 a[116:119], v[92:95], v[64:67], a[116:119]
    ds_read_b64_tr_b16 v[100:101], v13 offset:3072
    v_mfma_f32_16x16x32_bf16 a[120:123], v[92:95], v[68:71], a[120:123]
    ds_read_b64_tr_b16 v[102:103], v13 offset:4608
    v_mfma_f32_16x16x32_bf16 a[124:127], v[92:95], v[72:75], a[124:127]
    ds_read_b128 v[32:35], v14 offset:2048
    v_mfma_f32_16x16x32_bf16 a[128:131], v[92:95], v[76:79], a[128:131]
    ds_read_b128 v[36:39], v14 offset:6144
    v_mfma_f32_16x16x32_bf16 a[132:135], v[92:95], v[80:83], a[132:135]
    ds_read_b128 v[40:43], v14 offset:10240
    v_mfma_f32_16x16x32_bf16 a[136:139], v[92:95], v[84:87], a[136:139]
    s_waitcnt lgkmcnt(5)
    ds_read_b128 v[44:47], v14 offset:14336
    v_mfma_f32_16x16x32_bf16 a[140:143], v[96:99], v[60:63], a[140:143]
    v_mfma_f32_16x16x32_bf16 a[144:147], v[96:99], v[64:67], a[144:147]
    ds_read_b64_tr_b16 v[88:89], v13 offset:3104
    v_mfma_f32_16x16x32_bf16 a[148:151], v[96:99], v[68:71], a[148:151]
    ds_read_b64_tr_b16 v[90:91], v13 offset:4640
    v_mfma_f32_16x16x32_bf16 a[152:155], v[96:99], v[72:75], a[152:155]
    ds_read_b128 v[48:51], v14 offset:18432
    s_add_u32 m0, s32, 28672
    s_add_u32 s33, s47, 73920
    buffer_load_dwordx4 v10, s[24:27], s33 offen lds
    v_mfma_f32_16x16x32_bf16 a[156:159], v[96:99], v[76:79], a[156:159]
    ds_read_b128 v[52:55], v14 offset:22528
    s_add_u32 m0, s32, 29696
    s_nop 0
    buffer_load_dwordx4 v11, s[24:27], s33 offen lds
    v_mfma_f32_16x16x32_bf16 a[160:163], v[96:99], v[80:83], a[160:163]
    ds_read_b128 v[56:59], v14 offset:26624
    s_add_u32 m0, s32, 30720
    s_nop 0
    buffer_load_dwordx4 v12, s[24:27], s33 offen lds
    v_mfma_f32_16x16x32_bf16 a[164:167], v[96:99], v[84:87], a[164:167]
    s_waitcnt lgkmcnt(9)
    v_mfma_f32_16x16x32_bf16 a[168:171], v[100:103], v[60:63], a[168:171]
    v_mfma_f32_16x16x32_bf16 a[172:175], v[100:103], v[64:67], a[172:175]
    ds_read_b64_tr_b16 v[92:93], v13 offset:3136
    v_mfma_f32_16x16x32_bf16 a[176:179], v[100:103], v[68:71], a[176:179]
    ds_read_b64_tr_b16 v[94:95], v13 offset:4672
    v_mfma_f32_16x16x32_bf16 a[180:183], v[100:103], v[72:75], a[180:183]
    v_mfma_f32_16x16x32_bf16 a[184:187], v[100:103], v[76:79], a[184:187]
    v_mfma_f32_16x16x32_bf16 a[188:191], v[100:103], v[80:83], a[188:191]
    v_mfma_f32_16x16x32_bf16 a[192:195], v[100:103], v[84:87], a[192:195]
    s_waitcnt lgkmcnt(5)
    v_mfma_f32_16x16x32_bf16 a[196:199], v[88:91], v[60:63], a[196:199]
    s_waitcnt vmcnt(6)
    v_mfma_f32_16x16x32_bf16 a[200:203], v[88:91], v[64:67], a[200:203]
    ds_read_b64_tr_b16 v[96:97], v13 offset:6144
    v_mfma_f32_16x16x32_bf16 a[204:207], v[88:91], v[68:71], a[204:207]
    ds_read_b64_tr_b16 v[98:99], v13 offset:7680
    v_mfma_f32_16x16x32_bf16 a[208:211], v[88:91], v[72:75], a[208:211]
    v_mfma_f32_16x16x32_bf16 a[212:215], v[88:91], v[76:79], a[212:215]
    v_mfma_f32_16x16x32_bf16 a[216:219], v[88:91], v[80:83], a[216:219]
    v_mfma_f32_16x16x32_bf16 a[220:223], v[88:91], v[84:87], a[220:223]
    s_waitcnt lgkmcnt(2)
    v_mfma_f32_16x16x32_bf16 a[224:227], v[92:95], v[60:63], a[224:227]
    v_mfma_f32_16x16x32_bf16 a[228:231], v[92:95], v[64:67], a[228:231]
    ds_read_b64_tr_b16 v[100:101], v13 offset:6176
    v_mfma_f32_16x16x32_bf16 a[232:235], v[92:95], v[68:71], a[232:235]
    ds_read_b64_tr_b16 v[102:103], v13 offset:7712
    v_mfma_f32_16x16x32_bf16 a[236:239], v[92:95], v[72:75], a[236:239]
    s_add_u32 m0, s32, 31744
    s_add_u32 s33, s47, 110592
    buffer_load_dwordx4 v10, s[24:27], s33 offen lds
    v_mfma_f32_16x16x32_bf16 a[240:243], v[92:95], v[76:79], a[240:243]
    s_add_u32 m0, s32, 32768
    s_nop 0
    buffer_load_dwordx4 v11, s[24:27], s33 offen lds
    v_mfma_f32_16x16x32_bf16 a[244:247], v[92:95], v[80:83], a[244:247]
    s_add_u32 m0, s32, 33792
    s_nop 0
    buffer_load_dwordx4 v12, s[24:27], s33 offen lds
    v_mfma_f32_16x16x32_bf16 a[248:251], v[92:95], v[84:87], a[248:251]
    s_waitcnt lgkmcnt(2)
    v_mfma_f32_16x16x32_bf16 a[0:3], v[96:99], v[32:35], a[0:3]
    v_mfma_f32_16x16x32_bf16 a[4:7], v[96:99], v[36:39], a[4:7]
    ds_read_b64_tr_b16 v[88:89], v13 offset:6208
    v_mfma_f32_16x16x32_bf16 a[8:11], v[96:99], v[40:43], a[8:11]
    ds_read_b64_tr_b16 v[90:91], v13 offset:7744
    v_mfma_f32_16x16x32_bf16 a[12:15], v[96:99], v[44:47], a[12:15]
    v_mfma_f32_16x16x32_bf16 a[16:19], v[96:99], v[48:51], a[16:19]
    v_mfma_f32_16x16x32_bf16 a[20:23], v[96:99], v[52:55], a[20:23]
    v_mfma_f32_16x16x32_bf16 a[24:27], v[96:99], v[56:59], a[24:27]
    s_waitcnt lgkmcnt(2)
    v_mfma_f32_16x16x32_bf16 a[28:31], v[100:103], v[32:35], a[28:31]
    s_waitcnt vmcnt(6)
    v_mfma_f32_16x16x32_bf16 a[32:35], v[100:103], v[36:39], a[32:35]
    ds_read_b64_tr_b16 v[92:93], v13 offset:9216
    v_mfma_f32_16x16x32_bf16 a[36:39], v[100:103], v[40:43], a[36:39]
    ds_read_b64_tr_b16 v[94:95], v13 offset:10752
    v_mfma_f32_16x16x32_bf16 a[40:43], v[100:103], v[44:47], a[40:43]
    v_mfma_f32_16x16x32_bf16 a[44:47], v[100:103], v[48:51], a[44:47]
    v_mfma_f32_16x16x32_bf16 a[48:51], v[100:103], v[52:55], a[48:51]
    v_mfma_f32_16x16x32_bf16 a[52:55], v[100:103], v[56:59], a[52:55]
    s_waitcnt lgkmcnt(2)
    v_mfma_f32_16x16x32_bf16 a[56:59], v[88:91], v[32:35], a[56:59]
    v_mfma_f32_16x16x32_bf16 a[60:63], v[88:91], v[36:39], a[60:63]
    ds_read_b64_tr_b16 v[96:97], v13 offset:9248
    v_mfma_f32_16x16x32_bf16 a[64:67], v[88:91], v[40:43], a[64:67]
    ds_read_b64_tr_b16 v[98:99], v13 offset:10784
    v_mfma_f32_16x16x32_bf16 a[68:71], v[88:91], v[44:47], a[68:71]
    s_add_u32 m0, s32, 34816
    s_add_u32 s33, s47, 110688
    buffer_load_dwordx4 v10, s[24:27], s33 offen lds
    v_mfma_f32_16x16x32_bf16 a[72:75], v[88:91], v[48:51], a[72:75]
    s_add_u32 m0, s32, 35840
    s_nop 0
    buffer_load_dwordx4 v11, s[24:27], s33 offen lds
    v_mfma_f32_16x16x32_bf16 a[76:79], v[88:91], v[52:55], a[76:79]
    s_add_u32 m0, s32, 36864
    s_nop 0
    buffer_load_dwordx4 v12, s[24:27], s33 offen lds
    v_mfma_f32_16x16x32_bf16 a[80:83], v[88:91], v[56:59], a[80:83]
    s_waitcnt lgkmcnt(2)
    v_mfma_f32_16x16x32_bf16 a[84:87], v[92:95], v[32:35], a[84:87]
    v_mfma_f32_16x16x32_bf16 a[88:91], v[92:95], v[36:39], a[88:91]
    ds_read_b64_tr_b16 v[100:101], v13 offset:9280
    v_mfma_f32_16x16x32_bf16 a[92:95], v[92:95], v[40:43], a[92:95]
    ds_read_b64_tr_b16 v[102:103], v13 offset:10816
    v_mfma_f32_16x16x32_bf16 a[96:99], v[92:95], v[44:47], a[96:99]
    v_mfma_f32_16x16x32_bf16 a[100:103], v[92:95], v[48:51], a[100:103]
    v_mfma_f32_16x16x32_bf16 a[104:107], v[92:95], v[52:55], a[104:107]
    v_mfma_f32_16x16x32_bf16 a[108:111], v[92:95], v[56:59], a[108:111]
    s_waitcnt lgkmcnt(2)
    v_mfma_f32_16x16x32_bf16 a[112:115], v[96:99], v[32:35], a[112:115]
    s_waitcnt vmcnt(6)
    v_mfma_f32_16x16x32_bf16 a[116:119], v[96:99], v[36:39], a[116:119]
    ds_read_b64_tr_b16 v[88:89], v13 offset:0
    v_mfma_f32_16x16x32_bf16 a[120:123], v[96:99], v[40:43], a[120:123]
    ds_read_b64_tr_b16 v[90:91], v13 offset:1536
    v_mfma_f32_16x16x32_bf16 a[124:127], v[96:99], v[44:47], a[124:127]
    ds_read_b128 v[60:63], v14 offset:3072
    v_mfma_f32_16x16x32_bf16 a[128:131], v[96:99], v[48:51], a[128:131]
    ds_read_b128 v[64:67], v14 offset:7168
    v_mfma_f32_16x16x32_bf16 a[132:135], v[96:99], v[52:55], a[132:135]
    ds_read_b128 v[68:71], v14 offset:11264
    v_mfma_f32_16x16x32_bf16 a[136:139], v[96:99], v[56:59], a[136:139]
    s_waitcnt lgkmcnt(5)
    ds_read_b128 v[72:75], v14 offset:15360
    v_mfma_f32_16x16x32_bf16 a[140:143], v[100:103], v[32:35], a[140:143]
    v_mfma_f32_16x16x32_bf16 a[144:147], v[100:103], v[36:39], a[144:147]
    ds_read_b64_tr_b16 v[92:93], v13 offset:32
    v_mfma_f32_16x16x32_bf16 a[148:151], v[100:103], v[40:43], a[148:151]
    ds_read_b64_tr_b16 v[94:95], v13 offset:1568
    v_mfma_f32_16x16x32_bf16 a[152:155], v[100:103], v[44:47], a[152:155]
    ds_read_b128 v[76:79], v14 offset:19456
    s_add_u32 m0, s32, 37888
    s_add_u32 s33, s47, 110784
    buffer_load_dwordx4 v10, s[24:27], s33 offen lds
    v_mfma_f32_16x16x32_bf16 a[156:159], v[100:103], v[48:51], a[156:159]
    ds_read_b128 v[80:83], v14 offset:23552
    s_add_u32 m0, s32, 38912
    s_nop 0
    buffer_load_dwordx4 v11, s[24:27], s33 offen lds
    v_mfma_f32_16x16x32_bf16 a[160:163], v[100:103], v[52:55], a[160:163]
    ds_read_b128 v[84:87], v14 offset:27648
    s_add_u32 m0, s32, 39936
    s_nop 0
    buffer_load_dwordx4 v12, s[24:27], s33 offen lds
    v_mfma_f32_16x16x32_bf16 a[164:167], v[100:103], v[56:59], a[164:167]
    s_waitcnt lgkmcnt(9)
    v_mfma_f32_16x16x32_bf16 a[168:171], v[88:91], v[32:35], a[168:171]
    v_mfma_f32_16x16x32_bf16 a[172:175], v[88:91], v[36:39], a[172:175]
    ds_read_b64_tr_b16 v[96:97], v13 offset:64
    v_mfma_f32_16x16x32_bf16 a[176:179], v[88:91], v[40:43], a[176:179]
    ds_read_b64_tr_b16 v[98:99], v13 offset:1600
    v_mfma_f32_16x16x32_bf16 a[180:183], v[88:91], v[44:47], a[180:183]
    v_mfma_f32_16x16x32_bf16 a[184:187], v[88:91], v[48:51], a[184:187]
    v_mfma_f32_16x16x32_bf16 a[188:191], v[88:91], v[52:55], a[188:191]
    v_mfma_f32_16x16x32_bf16 a[192:195], v[88:91], v[56:59], a[192:195]
    s_waitcnt lgkmcnt(5)
    v_mfma_f32_16x16x32_bf16 a[196:199], v[92:95], v[32:35], a[196:199]
    s_waitcnt vmcnt(6)
    v_mfma_f32_16x16x32_bf16 a[200:203], v[92:95], v[36:39], a[200:203]
    ds_read_b64_tr_b16 v[100:101], v13 offset:3072
    v_mfma_f32_16x16x32_bf16 a[204:207], v[92:95], v[40:43], a[204:207]
    ds_read_b64_tr_b16 v[102:103], v13 offset:4608
    v_mfma_f32_16x16x32_bf16 a[208:211], v[92:95], v[44:47], a[208:211]
    v_mfma_f32_16x16x32_bf16 a[212:215], v[92:95], v[48:51], a[212:215]
    v_mfma_f32_16x16x32_bf16 a[216:219], v[92:95], v[52:55], a[216:219]
    v_mfma_f32_16x16x32_bf16 a[220:223], v[92:95], v[56:59], a[220:223]
    s_waitcnt lgkmcnt(2)
    v_mfma_f32_16x16x32_bf16 a[224:227], v[96:99], v[32:35], a[224:227]
    v_mfma_f32_16x16x32_bf16 a[228:231], v[96:99], v[36:39], a[228:231]
    ds_read_b64_tr_b16 v[88:89], v13 offset:3104
    v_mfma_f32_16x16x32_bf16 a[232:235], v[96:99], v[40:43], a[232:235]
    ds_read_b64_tr_b16 v[90:91], v13 offset:4640
    v_mfma_f32_16x16x32_bf16 a[236:239], v[96:99], v[44:47], a[236:239]
    s_add_u32 m0, s32, 28672
    s_add_u32 s33, s47, 147456
    buffer_load_dwordx4 v10, s[24:27], s33 offen lds
    v_mfma_f32_16x16x32_bf16 a[240:243], v[96:99], v[48:51], a[240:243]
    s_add_u32 m0, s32, 29696
    s_nop 0
    buffer_load_dwordx4 v11, s[24:27], s33 offen lds
    v_mfma_f32_16x16x32_bf16 a[244:247], v[96:99], v[52:55], a[244:247]
    s_add_u32 m0, s32, 30720
    s_nop 0
    buffer_load_dwordx4 v12, s[24:27], s33 offen lds
    v_mfma_f32_16x16x32_bf16 a[248:251], v[96:99], v[56:59], a[248:251]
    s_waitcnt lgkmcnt(2)
    v_mfma_f32_16x16x32_bf16 a[0:3], v[100:103], v[60:63], a[0:3]
    v_mfma_f32_16x16x32_bf16 a[4:7], v[100:103], v[64:67], a[4:7]
    ds_read_b64_tr_b16 v[92:93], v13 offset:3136
    v_mfma_f32_16x16x32_bf16 a[8:11], v[100:103], v[68:71], a[8:11]
    ds_read_b64_tr_b16 v[94:95], v13 offset:4672
    v_mfma_f32_16x16x32_bf16 a[12:15], v[100:103], v[72:75], a[12:15]
    v_mfma_f32_16x16x32_bf16 a[16:19], v[100:103], v[76:79], a[16:19]
    v_mfma_f32_16x16x32_bf16 a[20:23], v[100:103], v[80:83], a[20:23]
    v_mfma_f32_16x16x32_bf16 a[24:27], v[100:103], v[84:87], a[24:27]
    s_waitcnt lgkmcnt(2)
    v_mfma_f32_16x16x32_bf16 a[28:31], v[88:91], v[60:63], a[28:31]
    s_waitcnt vmcnt(6)
    v_mfma_f32_16x16x32_bf16 a[32:35], v[88:91], v[64:67], a[32:35]
    ds_read_b64_tr_b16 v[96:97], v13 offset:6144
    v_mfma_f32_16x16x32_bf16 a[36:39], v[88:91], v[68:71], a[36:39]
    ds_read_b64_tr_b16 v[98:99], v13 offset:7680
    v_mfma_f32_16x16x32_bf16 a[40:43], v[88:91], v[72:75], a[40:43]
    v_mfma_f32_16x16x32_bf16 a[44:47], v[88:91], v[76:79], a[44:47]
    v_mfma_f32_16x16x32_bf16 a[48:51], v[88:91], v[80:83], a[48:51]
    v_mfma_f32_16x16x32_bf16 a[52:55], v[88:91], v[84:87], a[52:55]
    s_waitcnt lgkmcnt(2)
    v_mfma_f32_16x16x32_bf16 a[56:59], v[92:95], v[60:63], a[56:59]
    v_mfma_f32_16x16x32_bf16 a[60:63], v[92:95], v[64:67], a[60:63]
    ds_read_b64_tr_b16 v[100:101], v13 offset:6176
    v_mfma_f32_16x16x32_bf16 a[64:67], v[92:95], v[68:71], a[64:67]
    ds_read_b64_tr_b16 v[102:103], v13 offset:7712
    v_mfma_f32_16x16x32_bf16 a[68:71], v[92:95], v[72:75], a[68:71]
    s_add_u32 m0, s32, 31744
    s_add_u32 s33, s47, 147552
    buffer_load_dwordx4 v10, s[24:27], s33 offen lds
    v_mfma_f32_16x16x32_bf16 a[72:75], v[92:95], v[76:79], a[72:75]
    s_add_u32 m0, s32, 32768
    s_nop 0
    buffer_load_dwordx4 v11, s[24:27], s33 offen lds
    v_mfma_f32_16x16x32_bf16 a[76:79], v[92:95], v[80:83], a[76:79]
    s_add_u32 m0, s32, 33792
    s_nop 0
    buffer_load_dwordx4 v12, s[24:27], s33 offen lds
    v_mfma_f32_16x16x32_bf16 a[80:83], v[92:95], v[84:87], a[80:83]
    s_waitcnt lgkmcnt(2)
    v_mfma_f32_16x16x32_bf16 a[84:87], v[96:99], v[60:63], a[84:87]
    v_mfma_f32_16x16x32_bf16 a[88:91], v[96:99], v[64:67], a[88:91]
    ds_read_b64_tr_b16 v[88:89], v13 offset:6208
    v_mfma_f32_16x16x32_bf16 a[92:95], v[96:99], v[68:71], a[92:95]
    ds_read_b64_tr_b16 v[90:91], v13 offset:7744
    v_mfma_f32_16x16x32_bf16 a[96:99], v[96:99], v[72:75], a[96:99]
    v_mfma_f32_16x16x32_bf16 a[100:103], v[96:99], v[76:79], a[100:103]
    v_mfma_f32_16x16x32_bf16 a[104:107], v[96:99], v[80:83], a[104:107]
    v_mfma_f32_16x16x32_bf16 a[108:111], v[96:99], v[84:87], a[108:111]
    s_waitcnt lgkmcnt(2)
    v_mfma_f32_16x16x32_bf16 a[112:115], v[100:103], v[60:63], a[112:115]
    s_waitcnt vmcnt(6)
    v_mfma_f32_16x16x32_bf16 a[116:119], v[100:103], v[64:67], a[116:119]
    ds_read_b64_tr_b16 v[92:93], v13 offset:9216
    v_mfma_f32_16x16x32_bf16 a[120:123], v[100:103], v[68:71], a[120:123]
    ds_read_b64_tr_b16 v[94:95], v13 offset:10752
    v_mfma_f32_16x16x32_bf16 a[124:127], v[100:103], v[72:75], a[124:127]
    ds_read_b128 v[32:35], v15 offset:0
    v_mfma_f32_16x16x32_bf16 a[128:131], v[100:103], v[76:79], a[128:131]
    ds_read_b128 v[36:39], v15 offset:4096
    v_mfma_f32_16x16x32_bf16 a[132:135], v[100:103], v[80:83], a[132:135]
    ds_read_b128 v[40:43], v15 offset:8192
    v_mfma_f32_16x16x32_bf16 a[136:139], v[100:103], v[84:87], a[136:139]
    s_waitcnt lgkmcnt(5)
    ds_read_b128 v[44:47], v15 offset:12288
    v_mfma_f32_16x16x32_bf16 a[140:143], v[88:91], v[60:63], a[140:143]
    v_mfma_f32_16x16x32_bf16 a[144:147], v[88:91], v[64:67], a[144:147]
    ds_read_b64_tr_b16 v[96:97], v13 offset:9248
    v_mfma_f32_16x16x32_bf16 a[148:151], v[88:91], v[68:71], a[148:151]
    ds_read_b64_tr_b16 v[98:99], v13 offset:10784
    v_mfma_f32_16x16x32_bf16 a[152:155], v[88:91], v[72:75], a[152:155]
    ds_read_b128 v[48:51], v15 offset:16384
    s_add_u32 m0, s32, 34816
    s_add_u32 s33, s47, 147648
    buffer_load_dwordx4 v10, s[24:27], s33 offen lds
    v_mfma_f32_16x16x32_bf16 a[156:159], v[88:91], v[76:79], a[156:159]
    ds_read_b128 v[52:55], v15 offset:20480
    s_add_u32 m0, s32, 35840
    s_nop 0
    buffer_load_dwordx4 v11, s[24:27], s33 offen lds
    v_mfma_f32_16x16x32_bf16 a[160:163], v[88:91], v[80:83], a[160:163]
    ds_read_b128 v[56:59], v15 offset:24576
    s_add_u32 m0, s32, 36864
    s_nop 0
    buffer_load_dwordx4 v12, s[24:27], s33 offen lds
    v_mfma_f32_16x16x32_bf16 a[164:167], v[88:91], v[84:87], a[164:167]
    s_waitcnt lgkmcnt(9)
    v_mfma_f32_16x16x32_bf16 a[168:171], v[92:95], v[60:63], a[168:171]
    v_mfma_f32_16x16x32_bf16 a[172:175], v[92:95], v[64:67], a[172:175]
    ds_read_b64_tr_b16 v[100:101], v13 offset:9280
    v_mfma_f32_16x16x32_bf16 a[176:179], v[92:95], v[68:71], a[176:179]
    ds_read_b64_tr_b16 v[102:103], v13 offset:10816
    v_mfma_f32_16x16x32_bf16 a[180:183], v[92:95], v[72:75], a[180:183]
    v_mfma_f32_16x16x32_bf16 a[184:187], v[92:95], v[76:79], a[184:187]
    v_mfma_f32_16x16x32_bf16 a[188:191], v[92:95], v[80:83], a[188:191]
    v_mfma_f32_16x16x32_bf16 a[192:195], v[92:95], v[84:87], a[192:195]
    s_waitcnt lgkmcnt(5)
    v_mfma_f32_16x16x32_bf16 a[196:199], v[96:99], v[60:63], a[196:199]
    s_waitcnt vmcnt(6)
    v_mfma_f32_16x16x32_bf16 a[200:203], v[96:99], v[64:67], a[200:203]
    ds_read_b64_tr_b16 v[88:89], v13 offset:0
    v_mfma_f32_16x16x32_bf16 a[204:207], v[96:99], v[68:71], a[204:207]
    ds_read_b64_tr_b16 v[90:91], v13 offset:1536
    v_mfma_f32_16x16x32_bf16 a[208:211], v[96:99], v[72:75], a[208:211]
    v_mfma_f32_16x16x32_bf16 a[212:215], v[96:99], v[76:79], a[212:215]
    v_mfma_f32_16x16x32_bf16 a[216:219], v[96:99], v[80:83], a[216:219]
    v_mfma_f32_16x16x32_bf16 a[220:223], v[96:99], v[84:87], a[220:223]
    s_waitcnt lgkmcnt(2)
    v_mfma_f32_16x16x32_bf16 a[224:227], v[100:103], v[60:63], a[224:227]
    v_mfma_f32_16x16x32_bf16 a[228:231], v[100:103], v[64:67], a[228:231]
    ds_read_b64_tr_b16 v[92:93], v13 offset:32
    v_mfma_f32_16x16x32_bf16 a[232:235], v[100:103], v[68:71], a[232:235]
    ds_read_b64_tr_b16 v[94:95], v13 offset:1568
    v_mfma_f32_16x16x32_bf16 a[236:239], v[100:103], v[72:75], a[236:239]
    s_add_u32 m0, s32, 37888
    s_add_u32 s33, s47, 184320
    buffer_load_dwordx4 v10, s[24:27], s33 offen lds
    v_mfma_f32_16x16x32_bf16 a[240:243], v[100:103], v[76:79], a[240:243]
    s_add_u32 m0, s32, 38912
    s_nop 0
    buffer_load_dwordx4 v11, s[24:27], s33 offen lds
    v_mfma_f32_16x16x32_bf16 a[244:247], v[100:103], v[80:83], a[244:247]
    s_add_u32 m0, s32, 39936
    s_nop 0
    buffer_load_dwordx4 v12, s[24:27], s33 offen lds
    v_mfma_f32_16x16x32_bf16 a[248:251], v[100:103], v[84:87], a[248:251]
    s_waitcnt lgkmcnt(2)
    s_add_u32 s47, s47, 147456
    v_add_u32 v14, 40960, v14
    v_add_u32 v15, 40960, v15
    s_mov_b32 s35, 0
L_O:
    v_mfma_f32_16x16x32_bf16 a[0:3], v[88:91], v[32:35], a[0:3]
    v_mfma_f32_16x16x32_bf16 a[4:7], v[88:91], v[36:39], a[4:7]
    ds_read_b64_tr_b16 v[96:97], v13 offset:64
    v_mfma_f32_16x16x32_bf16 a[8:11], v[88:91], v[40:43], a[8:11]
    ds_read_b64_tr_b16 v[98:99], v13 offset:1600
    v_mfma_f32_16x16x32_bf16 a[12:15], v[88:91], v[44:47], a[12:15]
    v_mfma_f32_16x16x32_bf16 a[16:19], v[88:91], v[48:51], a[16:19]
    v_mfma_f32_16x16x32_bf16 a[20:23], v[88:91], v[52:55], a[20:23]
    v_mfma_f32_16x16x32_bf16 a[24:27], v[88:91], v[56:59], a[24:27]
    s_waitcnt lgkmcnt(2)
    v_mfma_f32_16x16x32_bf16 a[28:31], v[92:95], v[32:35], a[28:31]
    s_waitcnt vmcnt(6)
    v_mfma_f32_16x16x32_bf16 a[32:35], v[92:95], v[36:39], a[32:35]
    ds_read_b64_tr_b16 v[100:101], v13 offset:3072
    v_mfma_f32_16x16x32_bf16 a[36:39], v[92:95], v[40:43], a[36:39]
    ds_read_b64_tr_b16 v[102:103], v13 offset:4608
    v_mfma_f32_16x16x32_bf16 a[40:43], v[92:95], v[44:47], a[40:43]
    v_mfma_f32_16x16x32_bf16 a[44:47], v[92:95], v[48:51], a[44:47]
    v_mfma_f32_16x16x32_bf16 a[48:51], v[92:95], v[52:55], a[48:51]
    v_mfma_f32_16x16x32_bf16 a[52:55], v[92:95], v[56:59], a[52:55]
    s_waitcnt lgkmcnt(2)
    v_mfma_f32_16x16x32_bf16 a[56:59], v[96:99], v[32:35], a[56:59]
    v_mfma_f32_16x16x32_bf16 a[60:63], v[96:99], v[36:39], a[60:63]
    ds_read_b64_tr_b16 v[88:89], v13 offset:3104
    v_mfma_f32_16x16x32_bf16 a[64:67], v[96:99], v[40:43], a[64:67]
    ds_read_b64_tr_b16 v[90:91], v13 offset:4640
    v_mfma_f32_16x16x32_bf16 a[68:71], v[96:99], v[44:47], a[68:71]
    s_add_u32 m0, s32, 28672
    s_add_u32 s33, s47, 36960
    buffer_load_dwordx4 v10, s[24:27], s33 offen lds
    v_mfma_f32_16x16x32_bf16 a[72:75], v[96:99], v[48:51], a[72:75]
    s_add_u32 m0, s32, 29696
    s_nop 0
    buffer_load_dwordx4 v11, s[24:27], s33 offen lds
    v_mfma_f32_16x16x32_bf16 a[76:79], v[96:99], v[52:55], a[76:79]
    s_add_u32 m0, s32, 30720
    s_nop 0
    buffer_load_dwordx4 v12, s[24:27], s33 offen lds
    v_mfma_f32_16x16x32_bf16 a[80:83], v[96:99], v[56:59], a[80:83]
    s_waitcnt lgkmcnt(2)
    v_mfma_f32_16x16x32_bf16 a[84:87], v[100:103], v[32:35], a[84:87]
    v_mfma_f32_16x16x32_bf16 a[88:91], v[100:103], v[36:39], a[88:91]
    ds_read_b64_tr_b16 v[92:93], v13 offset:3136
    v_mfma_f32_16x16x32_bf16 a[92:95], v[100:103], v[40:43], a[92:95]
    ds_read_b64_tr_b16 v[94:95], v13 offset:4672
    v_mfma_f32_16x16x32_bf16 a[96:99], v[100:103], v[44:47], a[96:99]
    v_mfma_f32_16x16x32_bf16 a[100:103], v[100:103], v[48:51], a[100:103]
    v_mfma_f32_16x16x32_bf16 a[104:107], v[100:103], v[52:55], a[104:107]
    v_mfma_f32_16x16x32_bf16 a[108:111], v[100:103], v[56:59], a[108:111]
    s_waitcnt lgkmcnt(2)
    v_mfma_f32_16x16x32_bf16 a[112:115], v[88:91], v[32:35], a[112:115]
    s_waitcnt vmcnt(6)
    v_mfma_f32_16x16x32_bf16 a[116:119], v[88:91], v[36:39], a[116:119]
    ds_read_b64_tr_b16 v[96:97], v13 offset:6144
    v_mfma_f32_16x16x32_bf16 a[120:123], v[88:91], v[40:43], a[120:123]
    ds_read_b64_tr_b16 v[98:99], v13 offset:7680
    v_mfma_f32_16x16x32_bf16 a[124:127], v[88:91], v[44:47], a[124:127]
    ds_read_b128 v[60:63], v14 offset:1024
    v_mfma_f32_16x16x32_bf16 a[128:131], v[88:91], v[48:51], a[128:131]
    ds_read_b128 v[64:67], v14 offset:5120
    v_mfma_f32_16x16x32_bf16 a[132:135], v[88:91], v[52:55], a[132:135]
    ds_read_b128 v[68:71], v14 offset:9216
    v_mfma_f32_16x16x32_bf16 a[136:139], v[88:91], v[56:59], a[136:139]
    s_waitcnt lgkmcnt(5)
    ds_read_b128 v[72:75], v14 offset:13312
    v_mfma_f32_16x16x32_bf16 a[140:143], v[92:95], v[32:35], a[140:143]
    v_mfma_f32_16x16x32_bf16 a[144:147], v[92:95], v[36:39], a[144:147]
    ds_read_b64_tr_b16 v[100:101], v13 offset:6176
    v_mfma_f32_16x16x32_bf16 a[148:151], v[92:95], v[40:43], a[148:151]
    ds_read_b64_tr_b16 v[102:103], v13 offset:7712
    v_mfma_f32_16x16x32_bf16 a[152:155], v[92:95], v[44:47], a[152:155]
    ds_read_b128 v[76:79], v14 offset:17408
    s_add_u32 m0, s32, 31744
    s_add_u32 s33, s47, 37056
    buffer_load_dwordx4 v10, s[24:27], s33 offen lds
    v_mfma_f32_16x16x32_bf16 a[156:159], v[92:95], v[48:51], a[156:159]
    ds_read_b128 v[80:83], v14 offset:21504
    s_add_u32 m0, s32, 32768
    s_nop 0
    buffer_load_dwordx4 v11, s[24:27], s33 offen lds
    v_mfma_f32_16x16x32_bf16 a[160:163], v[92:95], v[52:55], a[160:163]
    ds_read_b128 v[84:87], v14 offset:25600
    s_add_u32 m0, s32, 33792
    s_nop 0
    buffer_load_dwordx4 v12, s[24:27], s33 offen lds
    v_mfma_f32_16x16x32_bf16 a[164:167], v[92:95], v[56:59], a[164:167]
    s_waitcnt lgkmcnt(9)
    v_mfma_f32_16x16x32_bf16 a[168:171], v[96:99], v[32:35], a[168:171]
    v_mfma_f32_16x16x32_bf16 a[172:175], v[96:99], v[36:39], a[172:175]
    ds_read_b64_tr_b16 v[88:89], v13 offset:6208
    v_mfma_f32_16x16x32_bf16 a[176:179], v[96:99], v[40:43], a[176:179]
    ds_read_b64_tr_b16 v[90:91], v13 offset:7744
    v_mfma_f32_16x16x32_bf16 a[180:183], v[96:99], v[44:47], a[180:183]
    v_mfma_f32_16x16x32_bf16 a[184:187], v[96:99], v[48:51], a[184:187]
    v_mfma_f32_16x16x32_bf16 a[188:191], v[96:99], v[52:55], a[188:191]
    v_mfma_f32_16x16x32_bf16 a[192:195], v[96:99], v[56:59], a[192:195]
    s_waitcnt lgkmcnt(5)
    v_mfma_f32_16x16x32_bf16 a[196:199], v[100:103], v[32:35], a[196:199]
    s_waitcnt vmcnt(6)
    v_mfma_f32_16x16x32_bf16 a[200:203], v[100:103], v[36:39], a[200:203]
    ds_read_b64_tr_b16 v[92:93], v13 offset:9216
    v_mfma_f32_16x16x32_bf16 a[204:207], v[100:103], v[40:43], a[204:207]
    ds_read_b64_tr_b16 v[94:95], v13 offset:10752
    v_mfma_f32_16x16x32_bf16 a[208:211], v[100:103], v[44:47], a[208:211]
    v_mfma_f32_16x16x32_bf16 a[212:215], v[100:103], v[48:51], a[212:215]
    v_mfma_f32_16x16x32_bf16 a[216:219], v[100:103], v[52:55], a[216:219]
    v_mfma_f32_16x16x32_bf16 a[220:223], v[100:103], v[56:59], a[220:223]
    s_waitcnt lgkmcnt(2)
    v_mfma_f32_16x16x32_bf16 a[224:227], v[88:91], v[32:35], a[224:227]
    v_mfma_f32_16x16x32_bf16 a[228:231], v[88:91], v[36:39], a[228:231]
    ds_read_b64_tr_b16 v[96:97], v13 offset:9248
    v_mfma_f32_16x16x32_bf16 a[232:235], v[88:91], v[40:43], a[232:235]
    ds_read_b64_tr_b16 v[98:99], v13 offset:10784
    v_mfma_f32_16x16x32_bf16 a[236:239], v[88:91], v[44:47], a[236:239]
    s_add_u32 m0, s32, 34816
    s_add_u32 s33, s47, 73728
    buffer_load_dwordx4 v10, s[24:27], s33 offen lds
    v_mfma_f32_16x16x32_bf16 a[240:243], v[88:91], v[48:51], a[240:243]
    s_add_u32 m0, s32, 35840
    s_nop 0
    buffer_load_dwordx4 v11, s[24:27], s33 offen lds
    v_mfma_f32_16x16x32_bf16 a[244:247], v[88:91], v[52:55], a[244:247]
    s_add_u32 m0, s32, 36864
    s_nop 0
    buffer_load_dwordx4 v12, s[24:27], s33 offen lds
    v_mfma_f32_16x16x32_bf16 a[248:251], v[88:91], v[56:59], a[248:251]
    s_waitcnt lgkmcnt(2)
    v_mfma_f32_16x16x32_bf16 a[0:3], v[92:95], v[60:63], a[0:3]
    v_mfma_f32_16x16x32_bf16 a[4:7], v[92:95], v[64:67], a[4:7]
    ds_read_b64_tr_b16 v[100:101], v13 offset:9280
    v_mfma_f32_16x16x32_bf16 a[8:11], v[92:95], v[68:71], a[8:11]
    ds_read_b64_tr_b16 v[102:103], v13 offset:10816
    v_mfma_f32_16x16x32_bf16 a[12:15], v[92:95], v[72:75], a[12:15]
    v_mfma_f32_16x16x32_bf16 a[16:19], v[92:95], v[76:79], a[16:19]
    v_mfma_f32_16x16x32_bf16 a[20:23], v[92:95], v[80:83], a[20:23]
    v_mfma_f32_16x16x32_bf16 a[24:27], v[92:95], v[84:87], a[24:27]
    s_waitcnt lgkmcnt(2)
    v_mfma_f32_16x16x32_bf16 a[28:31], v[96:99], v[60:63], a[28:31]
    s_waitcnt vmcnt(6)
    v_mfma_f32_16x16x32_bf16 a[32:35], v[96:99], v[64:67], a[32:35]
    ds_read_b64_tr_b16 v[88:89], v13 offset:0
    v_mfma_f32_16x16x32_bf16 a[36:39], v[96:99], v[68:71], a[36:39]
    ds_read_b64_tr_b16 v[90:91], v13 offset:1536
    v_mfma_f32_16x16x32_bf16 a[40:43], v[96:99], v[72:75], a[40:43]
    v_mfma_f32_16x16x32_bf16 a[44:47], v[96:99], v[76:79], a[44:47]
    v_mfma_f32_16x16x32_bf16 a[48:51], v[96:99], v[80:83], a[48:51]
    v_mfma_f32_16x16x32_bf16 a[52:55], v[96:99], v[84:87], a[52:55]
    s_waitcnt lgkmcnt(2)
    v_mfma_f32_16x16x32_bf16 a[56:59], v[100:103], v[60:63], a[56:59]
    v_mfma_f32_16x16x32_bf16 a[60:63], v[100:103], v[64:67], a[60:63]
    ds_read_b64_tr_b16 v[92:93], v13 offset:32
    v_mfma_f32_16x16x32_bf16 a[64:67], v[100:103], v[68:71], a[64:67]
    ds_read_b64_tr_b16 v[94:95], v13 offset:1568
    v_mfma_f32_16x16x32_bf16 a[68:71], v[100:103], v[72:75], a[68:71]
    s_add_u32 m0, s32, 37888
    s_add_u32 s33, s47, 73824
    buffer_load_dwordx4 v10, s[24:27], s33 offen lds
    v_mfma_f32_16x16x32_bf16 a[72:75], v[100:103], v[76:79], a[72:75]
    s_add_u32 m0, s32, 38912
    s_nop 0
    buffer_load_dwordx4 v11, s[24:27], s33 offen lds
    v_mfma_f32_16x16x32_bf16 a[76:79], v[100:103], v[80:83], a[76:79]
    s_add_u32 m0, s32, 39936
    s_nop 0
    buffer_load_dwordx4 v12, s[24:27], s33 offen lds
    v_mfma_f32_16x16x32_bf16 a[80:83], v[100:103], v[84:87], a[80:83]
    s_waitcnt lgkmcnt(2)
    v_mfma_f32_16x16x32_bf16 a[84:87], v[88:91], v[60:63], a[84:87]
    v_mfma_f32_16x16x32_bf16 a[88:91], v[88:91], v[64:67], a[88:91]
    ds_read_b64_tr_b16 v[96:97], v13 offset:64
    v_mfma_f32_16x16x32_bf16 a[92:95], v[88:91], v[68:71], a[92:95]
    ds_read_b64_tr_b16 v[98:99], v13 offset:1600
    v_mfma_f32_16x16x32_bf16 a[96:99], v[88:91], v[72:75], a[96:99]
    v_mfma_f32_16x16x32_bf16 a[100:103], v[88:91], v[76:79], a[100:103]
    v_mfma_f32_16x16x32_bf16 a[104:107], v[88:91], v[80:83], a[104:107]
    v_mfma_f32_16x16x32_bf16 a[108:111], v[88:91], v[84:87], a[108:111]
    s_waitcnt lgkmcnt(2)
    v_mfma_f32_16x16x32_bf16 a[112:115], v[92:95], v[60:63], a[112:115]
    s_waitcnt vmcnt(6)
    v_mfma_f32_16x16x32_bf16 a[116:119], v[92:95], v[64:67], a[116:119]
    ds_read_b64_tr_b16 v[100:101], v13 offset:3072
    v_mfma_f32_16x16x32_bf16 a[120:123], v[92:95], v[68:71], a[120:123]
    ds_read_b64_tr_b16 v[102:103], v13 offset:4608
    v_mfma_f32_16x16x32_bf16 a[124:127], v[92:95], v[72:75], a[124:127]
    ds_read_b128 v[32:35], v14 offset:2048
    v_mfma_f32_16x16x32_bf16 a[128:131], v[92:95], v[76:79], a[128:131]
    ds_read_b128 v[36:39], v14 offset:6144
    v_mfma_f32_16x16x32_bf16 a[132:135], v[92:95], v[80:83], a[132:135]
    ds_read_b128 v[40:43], v14 offset:10240
    v_mfma_f32_16x16x32_bf16 a[136:139], v[92:95], v[84:87], a[136:139]
    s_waitcnt lgkmcnt(5)
    ds_read_b128 v[44:47], v14 offset:14336
    v_mfma_f32_16x16x32_bf16 a[140:143], v[96:99], v[60:63], a[140:143]
    v_mfma_f32_16x16x32_bf16 a[144:147], v[96:99], v[64:67], a[144:147]
    ds_read_b64_tr_b16 v[88:89], v13 offset:3104
    v_mfma_f32_16x16x32_bf16 a[148:151], v[96:99], v[68:71], a[148:151]
    ds_read_b64_tr_b16 v[90:91], v13 offset:4640
    v_mfma_f32_16x16x32_bf16 a[152:155], v[96:99], v[72:75], a[152:155]
    ds_read_b128 v[48:51], v14 offset:18432
    s_add_u32 m0, s32, 28672
    s_add_u32 s33, s47, 73920
    buffer_load_dwordx4 v10, s[24:27], s33 offen lds
    v_mfma_f32_16x16x32_bf16 a[156:159], v[96:99], v[76:79], a[156:159]
    ds_read_b128 v[52:55], v14 offset:22528
    s_add_u32 m0, s32, 29696
    s_nop 0
    buffer_load_dwordx4 v11, s[24:27], s33 offen lds
    v_mfma_f32_16x16x32_bf16 a[160:163], v[96:99], v[80:83], a[160:163]
    ds_read_b128 v[56:59], v14 offset:26624
    s_add_u32 m0, s32, 30720
    s_nop 0
    buffer_load_dwordx4 v12, s[24:27], s33 offen lds
    v_mfma_f32_16x16x32_bf16 a[164:167], v[96:99], v[84:87], a[164:167]
    s_waitcnt lgkmcnt(9)
    v_mfma_f32_16x16x32_bf16 a[168:171], v[100:103], v[60:63], a[168:171]
    v_mfma_f32_16x16x32_bf16 a[172:175], v[100:103], v[64:67], a[172:175]
    ds_read_b64_tr_b16 v[92:93], v13 offset:3136
    v_mfma_f32_16x16x32_bf16 a[176:179], v[100:103], v[68:71], a[176:179]
    ds_read_b64_tr_b16 v[94:95], v13 offset:4672
    v_mfma_f32_16x16x32_bf16 a[180:183], v[100:103], v[72:75], a[180:183]
    v_mfma_f32_16x16x32_bf16 a[184:187], v[100:103], v[76:79], a[184:187]
    v_mfma_f32_16x16x32_bf16 a[188:191], v[100:103], v[80:83], a[188:191]
    v_mfma_f32_16x16x32_bf16 a[192:195], v[100:103], v[84:87], a[192:195]
    s_waitcnt lgkmcnt(5)
    v_mfma_f32_16x16x32_bf16 a[196:199], v[88:91], v[60:63], a[196:199]
    s_waitcnt vmcnt(6)
    v_mfma_f32_16x16x32_bf16 a[200:203], v[88:91], v[64:67], a[200:203]
    ds_read_b64_tr_b16 v[96:97], v13 offset:6144
    v_mfma_f32_16x16x32_bf16 a[204:207], v[88:91], v[68:71], a[204:207]
    ds_read_b64_tr_b16 v[98:99], v13 offset:7680
    v_mfma_f32_16x16x32_bf16 a[208:211], v[88:91], v[72:75], a[208:211]
    v_mfma_f32_16x16x32_bf16 a[212:215], v[88:91], v[76:79], a[212:215]
    v_mfma_f32_16x16x32_bf16 a[216:219], v[88:91], v[80:83], a[216:219]
    v_mfma_f32_16x16x32_bf16 a[220:223], v[88:91], v[84:87], a[220:223]
    s_waitcnt lgkmcnt(2)
    v_mfma_f32_16x16x32_bf16 a[224:227], v[92:95], v[60:63], a[224:227]
    v_mfma_f32_16x16x32_bf16 a[228:231], v[92:95], v[64:67], a[228:231]
    ds_read_b64_tr_b16 v[100:101], v13 offset:6176
    v_mfma_f32_16x16x32_bf16 a[232:235], v[92:95], v[68:71], a[232:235]
    ds_read_b64_tr_b16 v[102:103], v13 offset:7712
    v_mfma_f32_16x16x32_bf16 a[236:239], v[92:95], v[72:75], a[236:239]
    s_add_u32 m0, s32, 31744
    s_add_u32 s33, s47, 110592
    buffer_load_dwordx4 v10, s[24:27], s33 offen lds
    v_mfma_f32_16x16x32_bf16 a[240:243], v[92:95], v[76:79], a[240:243]
    s_add_u32 m0, s32, 32768
    s_nop 0
    buffer_load_dwordx4 v11, s[24:27], s33 offen lds
    v_mfma_f32_16x16x32_bf16 a[244:247], v[92:95], v[80:83], a[244:247]
    s_add_u32 m0, s32, 33792
    s_nop 0
    buffer_load_dwordx4 v12, s[24:27], s33 offen lds
    v_mfma_f32_16x16x32_bf16 a[248:251], v[92:95], v[84:87], a[248:251]
    s_waitcnt lgkmcnt(2)
    v_mfma_f32_16x16x32_bf16 a[0:3], v[96:99], v[32:35], a[0:3]
    v_mfma_f32_16x16x32_bf16 a[4:7], v[96:99], v[36:39], a[4:7]
    ds_read_b64_tr_b16 v[88:89], v13 offset:6208
    v_mfma_f32_16x16x32_bf16 a[8:11], v[96:99], v[40:43], a[8:11]
    ds_read_b64_tr_b16 v[90:91], v13 offset:7744
    v_mfma_f32_16x16x32_bf16 a[12:15], v[96:99], v[44:47], a[12:15]
    v_mfma_f32_16x16x32_bf16 a[16:19], v[96:99], v[48:51], a[16:19]
    v_mfma_f32_16x16x32_bf16 a[20:23], v[96:99], v[52:55], a[20:23]
    v_mfma_f32_16x16x32_bf16 a[24:27], v[96:99], v[56:59], a[24:27]
    s_waitcnt lgkmcnt(2)
    v_mfma_f32_16x16x32_bf16 a[28:31], v[100:103], v[32:35], a[28:31]
    s_waitcnt vmcnt(6)
    v_mfma_f32_16x16x32_bf16 a[32:35], v[100:103], v[36:39], a[32:35]
    ds_read_b64_tr_b16 v[92:93], v13 offset:9216
    v_mfma_f32_16x16x32_bf16 a[36:39], v[100:103], v[40:43], a[36:39]
    ds_read_b64_tr_b16 v[94:95], v13 offset:10752
    v_mfma_f32_16x16x32_bf16 a[40:43], v[100:103], v[44:47], a[40:43]
    v_mfma_f32_16x16x32_bf16 a[44:47], v[100:103], v[48:51], a[44:47]
    v_mfma_f32_16x16x32_bf16 a[48:51], v[100:103], v[52:55], a[48:51]
    v_mfma_f32_16x16x32_bf16 a[52:55], v[100:103], v[56:59], a[52:55]
    s_waitcnt lgkmcnt(2)
    v_mfma_f32_16x16x32_bf16 a[56:59], v[88:91], v[32:35], a[56:59]
    v_mfma_f32_16x16x32_bf16 a[60:63], v[88:91], v[36:39], a[60:63]
    ds_read_b64_tr_b16 v[96:97], v13 offset:9248
    v_mfma_f32_16x16x32_bf16 a[64:67], v[88:91], v[40:43], a[64:67]
    ds_read_b64_tr_b16 v[98:99], v13 offset:10784
    v_mfma_f32_16x16x32_bf16 a[68:71], v[88:91], v[44:47], a[68:71]
    s_add_u32 m0, s32, 34816
    s_add_u32 s33, s47, 110688
    buffer_load_dwordx4 v10, s[24:27], s33 offen lds
    v_mfma_f32_16x16x32_bf16 a[72:75], v[88:91], v[48:51], a[72:75]
    s_add_u32 m0, s32, 35840
    s_nop 0
    buffer_load_dwordx4 v11, s[24:27], s33 offen lds
    v_mfma_f32_16x16x32_bf16 a[76:79], v[88:91], v[52:55], a[76:79]
    s_add_u32 m0, s32, 36864
    s_nop 0
    buffer_load_dwordx4 v12, s[24:27], s33 offen lds
    v_mfma_f32_16x16x32_bf16 a[80:83], v[88:91], v[56:59], a[80:83]
    s_waitcnt lgkmcnt(2)
    v_mfma_f32_16x16x32_bf16 a[84:87], v[92:95], v[32:35], a[84:87]
    v_mfma_f32_16x16x32_bf16 a[88:91], v[92:95], v[36:39], a[88:91]
    ds_read_b64_tr_b16 v[100:101], v13 offset:9280
    v_mfma_f32_16x16x32_bf16 a[92:95], v[92:95], v[40:43], a[92:95]
    ds_read_b64_tr_b16 v[102:103], v13 offset:10816
    v_mfma_f32_16x16x32_bf16 a[96:99], v[92:95], v[44:47], a[96:99]
    v_mfma_f32_16x16x32_bf16 a[100:103], v[92:95], v[48:51], a[100:103]
    v_mfma_f32_16x16x32_bf16 a[104:107], v[92:95], v[52:55], a[104:107]
    v_mfma_f32_16x16x32_bf16 a[108:111], v[92:95], v[56:59], a[108:111]
    s_waitcnt lgkmcnt(2)
    v_mfma_f32_16x16x32_bf16 a[112:115], v[96:99], v[32:35], a[112:115]
    s_waitcnt vmcnt(6)
    v_mfma_f32_16x16x32_bf16 a[116:119], v[96:99], v[36:39], a[116:119]
    ds_read_b64_tr_b16 v[88:89], v13 offset:0
    v_mfma_f32_16x16x32_bf16 a[120:123], v[96:99], v[40:43], a[120:123]
    ds_read_b64_tr_b16 v[90:91], v13 offset:1536
    v_mfma_f32_16x16x32_bf16 a[124:127], v[96:99], v[44:47], a[124:127]
    ds_read_b128 v[60:63], v14 offset:3072
    v_mfma_f32_16x16x32_bf16 a[128:131], v[96:99], v[48:51], a[128:131]
    ds_read_b128 v[64:67], v14 offset:7168
    v_mfma_f32_16x16x32_bf16 a[132:135], v[96:99], v[52:55], a[132:135]
    ds_read_b128 v[68:71], v14 offset:11264
    v_mfma_f32_16x16x32_bf16 a[136:139], v[96:99], v[56:59], a[136:139]
    s_waitcnt lgkmcnt(5)
    ds_read_b128 v[72:75], v14 offset:15360
    v_mfma_f32_16x16x32_bf16 a[140:143], v[100:103], v[32:35], a[140:143]
    v_mfma_f32_16x16x32_bf16 a[144:147], v[100:103], v[36:39], a[144:147]
    ds_read_b64_tr_b16 v[92:93], v13 offset:32
    v_mfma_f32_16x16x32_bf16 a[148:151], v[100:103], v[40:43], a[148:151]
    ds_read_b64_tr_b16 v[94:95], v13 offset:1568
    v_mfma_f32_16x16x32_bf16 a[152:155], v[100:103], v[44:47], a[152:155]
    ds_read_b128 v[76:79], v14 offset:19456
    s_add_u32 m0, s32, 37888
    s_add_u32 s33, s47, 110784
    buffer_load_dwordx4 v10, s[24:27], s33 offen lds
    v_mfma_f32_16x16x32_bf16 a[156:159], v[100:103], v[48:51], a[156:159]
    ds_read_b128 v[80:83], v14 offset:23552
    s_add_u32 m0, s32, 38912
    s_nop 0
    buffer_load_dwordx4 v11, s[24:27], s33 offen lds
    v_mfma_f32_16x16x32_bf16 a[160:163], v[100:103], v[52:55], a[160:163]
    ds_read_b128 v[84:87], v14 offset:27648
    s_add_u32 m0, s32, 39936
    s_nop 0
    buffer_load_dwordx4 v12, s[24:27], s33 offen lds
    v_mfma_f32_16x16x32_bf16 a[164:167], v[100:103], v[56:59], a[164:167]
    s_waitcnt lgkmcnt(9)
    v_mfma_f32_16x16x32_bf16 a[168:171], v[88:91], v[32:35], a[168:171]
    v_mfma_f32_16x16x32_bf16 a[172:175], v[88:91], v[36:39], a[172:175]
    ds_read_b64_tr_b16 v[96:97], v13 offset:64
    v_mfma_f32_16x16x32_bf16 a[176:179], v[88:91], v[40:43], a[176:179]
    ds_read_b64_tr_b16 v[98:99], v13 offset:1600
    v_mfma_f32_16x16x32_bf16 a[180:183], v[88:91], v[44:47], a[180:183]
    v_mfma_f32_16x16x32_bf16 a[184:187], v[88:91], v[48:51], a[184:187]
    v_mfma_f32_16x16x32_bf16 a[188:191], v[88:91], v[52:55], a[188:191]
    v_mfma_f32_16x16x32_bf16 a[192:195], v[88:91], v[56:59], a[192:195]
    s_waitcnt lgkmcnt(5)
    v_mfma_f32_16x16x32_bf16 a[196:199], v[92:95], v[32:35], a[196:199]
    s_waitcnt vmcnt(6)
    v_mfma_f32_16x16x32_bf16 a[200:203], v[92:95], v[36:39], a[200:203]
    ds_read_b64_tr_b16 v[100:101], v13 offset:3072
    v_mfma_f32_16x16x32_bf16 a[204:207], v[92:95], v[40:43], a[204:207]
    ds_read_b64_tr_b16 v[102:103], v13 offset:4608
    v_mfma_f32_16x16x32_bf16 a[208:211], v[92:95], v[44:47], a[208:211]
    v_mfma_f32_16x16x32_bf16 a[212:215], v[92:95], v[48:51], a[212:215]
    v_mfma_f32_16x16x32_bf16 a[216:219], v[92:95], v[52:55], a[216:219]
    v_mfma_f32_16x16x32_bf16 a[220:223], v[92:95], v[56:59], a[220:223]
    s_waitcnt lgkmcnt(2)
    v_mfma_f32_16x16x32_bf16 a[224:227], v[96:99], v[32:35], a[224:227]
    v_mfma_f32_16x16x32_bf16 a[228:231], v[96:99], v[36:39], a[228:231]
    ds_read_b64_tr_b16 v[88:89], v13 offset:3104
    v_mfma_f32_16x16x32_bf16 a[232:235], v[96:99], v[40:43], a[232:235]
    ds_read_b64_tr_b16 v[90:91], v13 offset:4640
    v_mfma_f32_16x16x32_bf16 a[236:239], v[96:99], v[44:47], a[236:239]
    s_add_u32 m0, s32, 28672
    s_add_u32 s33, s47, 147456
    buffer_load_dwordx4 v10, s[24:27], s33 offen lds
    v_mfma_f32_16x16x32_bf16 a[240:243], v[96:99], v[48:51], a[240:243]
    s_add_u32 m0, s32, 29696
    s_nop 0
    buffer_load_dwordx4 v11, s[24:27], s33 offen lds
    v_mfma_f32_16x16x32_bf16 a[244:247], v[96:99], v[52:55], a[244:247]
    s_add_u32 m0, s32, 30720
    s_nop 0
    buffer_load_dwordx4 v12, s[24:27], s33 offen lds
    v_mfma_f32_16x16x32_bf16 a[248:251], v[96:99], v[56:59], a[248:251]
    s_waitcnt lgkmcnt(2)
    v_mfma_f32_16x16x32_bf16 a[0:3], v[100:103], v[60:63], a[0:3]
    v_mfma_f32_16x16x32_bf16 a[4:7], v[100:103], v[64:67], a[4:7]
    ds_read_b64_tr_b16 v[92:93], v13 offset:3136
    v_mfma_f32_16x16x32_bf16 a[8:11], v[100:103], v[68:71], a[8:11]
    ds_read_b64_tr_b16 v[94:95], v13 offset:4672
    v_mfma_f32_16x16x32_bf16 a[12:15], v[100:103], v[72:75], a[12:15]
    v_mfma_f32_16x16x32_bf16 a[16:19], v[100:103], v[76:79], a[16:19]
    v_mfma_f32_16x16x32_bf16 a[20:23], v[100:103], v[80:83], a[20:23]
    v_mfma_f32_16x16x32_bf16 a[24:27], v[100:103], v[84:87], a[24:27]
    s_waitcnt lgkmcnt(2)
    v_mfma_f32_16x16x32_bf16 a[28:31], v[88:91], v[60:63], a[28:31]
    s_waitcnt vmcnt(6)
    v_mfma_f32_16x16x32_bf16 a[32:35], v[88:91], v[64:67], a[32:35]
    ds_read_b64_tr_b16 v[96:97], v13 offset:6144
    v_mfma_f32_16x16x32_bf16 a[36:39], v[88:91], v[68:71], a[36:39]
    ds_read_b64_tr_b16 v[98:99], v13 offset:7680
    v_mfma_f32_16x16x32_bf16 a[40:43], v[88:91], v[72:75], a[40:43]
    v_mfma_f32_16x16x32_bf16 a[44:47], v[88:91], v[76:79], a[44:47]
    v_mfma_f32_16x16x32_bf16 a[48:51], v[88:91], v[80:83], a[48:51]
    v_mfma_f32_16x16x32_bf16 a[52:55], v[88:91], v[84:87], a[52:55]
    s_waitcnt lgkmcnt(2)
    v_mfma_f32_16x16x32_bf16 a[56:59], v[92:95], v[60:63], a[56:59]
    v_mfma_f32_16x16x32_bf16 a[60:63], v[92:95], v[64:67], a[60:63]
    ds_read_b64_tr_b16 v[100:101], v13 offset:6176
    v_mfma_f32_16x16x32_bf16 a[64:67], v[92:95], v[68:71], a[64:67]
    ds_read_b64_tr_b16 v[102:103], v13 offset:7712
    v_mfma_f32_16x16x32_bf16 a[68:71], v[92:95], v[72:75], a[68:71]
    s_add_u32 m0, s32, 31744
    s_add_u32 s33, s47, 147552
    buffer_load_dwordx4 v10, s[24:27], s33 offen lds
    v_mfma_f32_16x16x32_bf16 a[72:75], v[92:95], v[76:79], a[72:75]
    s_add_u32 m0, s32, 32768
    s_nop 0
    buffer_load_dwordx4 v11, s[24:27], s33 offen lds
    v_mfma_f32_16x16x32_bf16 a[76:79], v[92:95], v[80:83], a[76:79]
    s_add_u32 m0, s32, 33792
    s_nop 0
    buffer_load_dwordx4 v12, s[24:27], s33 offen lds
    v_mfma_f32_16x16x32_bf16 a[80:83], v[92:95], v[84:87], a[80:83]
    s_waitcnt lgkmcnt(2)
    v_mfma_f32_16x16x32_bf16 a[84:87], v[96:99], v[60:63], a[84:87]
    v_mfma_f32_16x16x32_bf16 a[88:91], v[96:99], v[64:67], a[88:91]
    ds_read_b64_tr_b16 v[88:89], v13 offset:6208
    v_mfma_f32_16x16x32_bf16 a[92:95], v[96:99], v[68:71], a[92:95]
    ds_read_b64_tr_b16 v[90:91], v13 offset:7744
    v_mfma_f32_16x16x32_bf16 a[96:99], v[96:99], v[72:75], a[96:99]
    v_mfma_f32_16x16x32_bf16 a[100:103], v[96:99], v[76:79], a[100:103]
    v_mfma_f32_16x16x32_bf16 a[104:107], v[96:99], v[80:83], a[104:107]
    v_mfma_f32_16x16x32_bf16 a[108:111], v[96:99], v[84:87], a[108:111]
    s_waitcnt lgkmcnt(2)
    v_mfma_f32_16x16x32_bf16 a[112:115], v[100:103], v[60:63], a[112:115]
    s_waitcnt vmcnt(6)
    v_mfma_f32_16x16x32_bf16 a[116:119], v[100:103], v[64:67], a[116:119]
    ds_read_b64_tr_b16 v[92:93], v13 offset:9216
    v_mfma_f32_16x16x32_bf16 a[120:123], v[100:103], v[68:71], a[120:123]
    ds_read_b64_tr_b16 v[94:95], v13 offset:10752
    v_mfma_f32_16x16x32_bf16 a[124:127], v[100:103], v[72:75], a[124:127]
    ds_read_b128 v[32:35], v15 offset:0
    v_mfma_f32_16x16x32_bf16 a[128:131], v[100:103], v[76:79], a[128:131]
    ds_read_b128 v[36:39], v15 offset:4096
    v_mfma_f32_16x16x32_bf16 a[132:135], v[100:103], v[80:83], a[132:135]
    ds_read_b128 v[40:43], v15 offset:8192
    v_mfma_f32_16x16x32_bf16 a[136:139], v[100:103], v[84:87], a[136:139]
    s_waitcnt lgkmcnt(5)
    ds_read_b128 v[44:47], v15 offset:12288
    v_mfma_f32_16x16x32_bf16 a[140:143], v[88:91], v[60:63], a[140:143]
    v_mfma_f32_16x16x32_bf16 a[144:147], v[88:91], v[64:67], a[144:147]
    ds_read_b64_tr_b16 v[96:97], v13 offset:9248
    v_mfma_f32_16x16x32_bf16 a[148:151], v[88:91], v[68:71], a[148:151]
    ds_read_b64_tr_b16 v[98:99], v13 offset:10784
    v_mfma_f32_16x16x32_bf16 a[152:155], v[88:91], v[72:75], a[152:155]
    ds_read_b128 v[48:51], v15 offset:16384
    s_add_u32 m0, s32, 34816
    s_add_u32 s33, s47, 147648
    buffer_load_dwordx4 v10, s[24:27], s33 offen lds
    v_mfma_f32_16x16x32_bf16 a[156:159], v[88:91], v[76:79], a[156:159]
    ds_read_b128 v[52:55], v15 offset:20480
    s_add_u32 m0, s32, 35840
    s_nop 0
    buffer_load_dwordx4 v11, s[24:27], s33 offen lds
    v_mfma_f32_16x16x32_bf16 a[160:163], v[88:91], v[80:83], a[160:163]
    ds_read_b128 v[56:59], v15 offset:24576
    s_add_u32 m0, s32, 36864
    s_nop 0
    buffer_load_dwordx4 v12, s[24:27], s33 offen lds
    v_mfma_f32_16x16x32_bf16 a[164:167], v[88:91], v[84:87], a[164:167]
    s_waitcnt lgkmcnt(9)
    v_mfma_f32_16x16x32_bf16 a[168:171], v[92:95], v[60:63], a[168:171]
    v_mfma_f32_16x16x32_bf16 a[172:175], v[92:95], v[64:67], a[172:175]
    ds_read_b64_tr_b16 v[100:101], v13 offset:9280
    v_mfma_f32_16x16x32_bf16 a[176:179], v[92:95], v[68:71], a[176:179]
    ds_read_b64_tr_b16 v[102:103], v13 offset:10816
    v_mfma_f32_16x16x32_bf16 a[180:183], v[92:95], v[72:75], a[180:183]
    v_mfma_f32_16x16x32_bf16 a[184:187], v[92:95], v[76:79], a[184:187]
    v_mfma_f32_16x16x32_bf16 a[188:191], v[92:95], v[80:83], a[188:191]
    v_mfma_f32_16x16x32_bf16 a[192:195], v[92:95], v[84:87], a[192:195]
    s_waitcnt lgkmcnt(5)
    v_mfma_f32_16x16x32_bf16 a[196:199], v[96:99], v[60:63], a[196:199]
    s_waitcnt vmcnt(6)
    v_mfma_f32_16x16x32_bf16 a[200:203], v[96:99], v[64:67], a[200:203]
    ds_read_b64_tr_b16 v[88:89], v13 offset:0
    v_mfma_f32_16x16x32_bf16 a[204:207], v[96:99], v[68:71], a[204:207]
    ds_read_b64_tr_b16 v[90:91], v13 offset:1536
    v_mfma_f32_16x16x32_bf16 a[208:211], v[96:99], v[72:75], a[208:211]
    v_mfma_f32_16x16x32_bf16 a[212:215], v[96:99], v[76:79], a[212:215]
    v_mfma_f32_16x16x32_bf16 a[216:219], v[96:99], v[80:83], a[216:219]
    v_mfma_f32_16x16x32_bf16 a[220:223], v[96:99], v[84:87], a[220:223]
    s_waitcnt lgkmcnt(2)
    v_mfma_f32_16x16x32_bf16 a[224:227], v[100:103], v[60:63], a[224:227]
    v_mfma_f32_16x16x32_bf16 a[228:231], v[100:103], v[64:67], a[228:231]
    ds_read_b64_tr_b16 v[92:93], v13 offset:32
    v_mfma_f32_16x16x32_bf16 a[232:235], v[100:103], v[68:71], a[232:235]
    ds_read_b64_tr_b16 v[94:95], v13 offset:1568
    v_mfma_f32_16x16x32_bf16 a[236:239], v[100:103], v[72:75], a[236:239]
    s_add_u32 m0, s32, 37888
    s_add_u32 s33, s47, 184320
    buffer_load_dwordx4 v10, s[24:27], s33 offen lds
    v_mfma_f32_16x16x32_bf16 a[240:243], v[100:103], v[76:79], a[240:243]
    s_add_u32 m0, s32, 38912
    s_nop 0
    buffer_load_dwordx4 v11, s[24:27], s33 offen lds
    v_mfma_f32_16x16x32_bf16 a[244:247], v[100:103], v[80:83], a[244:247]
    s_add_u32 m0, s32, 39936
    s_nop 0
    buffer_load_dwordx4 v12, s[24:27], s33 offen lds
    v_mfma_f32_16x16x32_bf16 a[248:251], v[100:103], v[84:87], a[248:251]
    s_waitcnt lgkmcnt(2)
    s_add_u32 s47, s47, 147456
    v_add_u32 v14, 40960, v14
    v_add_u32 v15, 40960, v15
    s_add_u32 s35, s35, 1
    s_cmp_lt_u32 s35, 2
    s_cbranch_scc1 L_O
    v_lshlrev_b32 v1, 4, v0
    v_mfma_f32_16x16x32_bf16 a[0:3], v[88:91], v[32:35], a[0:3]
    v_mfma_f32_16x16x32_bf16 a[4:7], v[88:91], v[36:39], a[4:7]
    ds_read_b64_tr_b16 v[96:97], v13 offset:64
    v_mfma_f32_16x16x32_bf16 a[8:11], v[88:91], v[40:43], a[8:11]
    ds_read_b64_tr_b16 v[98:99], v13 offset:1600
    v_mfma_f32_16x16x32_bf16 a[12:15], v[88:91], v[44:47], a[12:15]
    v_mfma_f32_16x16x32_bf16 a[16:19], v[88:91], v[48:51], a[16:19]
    v_mfma_f32_16x16x32_bf16 a[20:23], v[88:91], v[52:55], a[20:23]
    v_mfma_f32_16x16x32_bf16 a[24:27], v[88:91], v[56:59], a[24:27]
    s_waitcnt lgkmcnt(2)
    v_mfma_f32_16x16x32_bf16 a[28:31], v[92:95], v[32:35], a[28:31]
    s_waitcnt vmcnt(6)
    v_mfma_f32_16x16x32_bf16 a[32:35], v[92:95], v[36:39], a[32:35]
    ds_read_b64_tr_b16 v[100:101], v13 offset:3072
    v_mfma_f32_16x16x32_bf16 a[36:39], v[92:95], v[40:43], a[36:39]
    ds_read_b64_tr_b16 v[102:103], v13 offset:4608
    v_mfma_f32_16x16x32_bf16 a[40:43], v[92:95], v[44:47], a[40:43]
    v_mfma_f32_16x16x32_bf16 a[44:47], v[92:95], v[48:51], a[44:47]
    v_mfma_f32_16x16x32_bf16 a[48:51], v[92:95], v[52:55], a[48:51]
    v_mfma_f32_16x16x32_bf16 a[52:55], v[92:95], v[56:59], a[52:55]
    s_waitcnt lgkmcnt(2)
    v_mfma_f32_16x16x32_bf16 a[56:59], v[96:99], v[32:35], a[56:59]
    v_mfma_f32_16x16x32_bf16 a[60:63], v[96:99], v[36:39], a[60:63]
    ds_read_b64_tr_b16 v[88:89], v13 offset:3104
    v_mfma_f32_16x16x32_bf16 a[64:67], v[96:99], v[40:43], a[64:67]
    ds_read_b64_tr_b16 v[90:91], v13 offset:4640
    v_mfma_f32_16x16x32_bf16 a[68:71], v[96:99], v[44:47], a[68:71]
    s_add_u32 m0, s32, 28672
    s_add_u32 s33, s47, 36960
    buffer_load_dwordx4 v10, s[24:27], s33 offen lds
    v_mfma_f32_16x16x32_bf16 a[72:75], v[96:99], v[48:51], a[72:75]
    s_add_u32 m0, s32, 29696
    s_nop 0
    buffer_load_dwordx4 v11, s[24:27], s33 offen lds
    v_mfma_f32_16x16x32_bf16 a[76:79], v[96:99], v[52:55], a[76:79]
    s_add_u32 m0, s32, 30720
    s_nop 0
    buffer_load_dwordx4 v12, s[24:27], s33 offen lds
    v_mfma_f32_16x16x32_bf16 a[80:83], v[96:99], v[56:59], a[80:83]
    s_waitcnt lgkmcnt(2)
    v_mfma_f32_16x16x32_bf16 a[84:87], v[100:103], v[32:35], a[84:87]
    v_mfma_f32_16x16x32_bf16 a[88:91], v[100:103], v[36:39], a[88:91]
    ds_read_b64_tr_b16 v[92:93], v13 offset:3136
    v_mfma_f32_16x16x32_bf16 a[92:95], v[100:103], v[40:43], a[92:95]
    ds_read_b64_tr_b16 v[94:95], v13 offset:4672
    v_mfma_f32_16x16x32_bf16 a[96:99], v[100:103], v[44:47], a[96:99]
    v_mfma_f32_16x16x32_bf16 a[100:103], v[100:103], v[48:51], a[100:103]
    v_mfma_f32_16x16x32_bf16 a[104:107], v[100:103], v[52:55], a[104:107]
    v_mfma_f32_16x16x32_bf16 a[108:111], v[100:103], v[56:59], a[108:111]
    s_waitcnt lgkmcnt(2)
    v_mfma_f32_16x16x32_bf16 a[112:115], v[88:91], v[32:35], a[112:115]
    s_waitcnt vmcnt(6)
    v_mfma_f32_16x16x32_bf16 a[116:119], v[88:91], v[36:39], a[116:119]
    ds_read_b64_tr_b16 v[96:97], v13 offset:6144
    v_mfma_f32_16x16x32_bf16 a[120:123], v[88:91], v[40:43], a[120:123]
    ds_read_b64_tr_b16 v[98:99], v13 offset:7680
    v_mfma_f32_16x16x32_bf16 a[124:127], v[88:91], v[44:47], a[124:127]
    ds_read_b128 v[60:63], v14 offset:1024
    v_mfma_f32_16x16x32_bf16 a[128:131], v[88:91], v[48:51], a[128:131]
    ds_read_b128 v[64:67], v14 offset:5120
    v_mfma_f32_16x16x32_bf16 a[132:135], v[88:91], v[52:55], a[132:135]
    ds_read_b128 v[68:71], v14 offset:9216
    v_mfma_f32_16x16x32_bf16 a[136:139], v[88:91], v[56:59], a[136:139]
    s_waitcnt lgkmcnt(5)
    ds_read_b128 v[72:75], v14 offset:13312
    v_mfma_f32_16x16x32_bf16 a[140:143], v[92:95], v[32:35], a[140:143]
    v_mfma_f32_16x16x32_bf16 a[144:147], v[92:95], v[36:39], a[144:147]
    ds_read_b64_tr_b16 v[100:101], v13 offset:6176
    v_mfma_f32_16x16x32_bf16 a[148:151], v[92:95], v[40:43], a[148:151]
    ds_read_b64_tr_b16 v[102:103], v13 offset:7712
    v_mfma_f32_16x16x32_bf16 a[152:155], v[92:95], v[44:47], a[152:155]
    ds_read_b128 v[76:79], v14 offset:17408
    s_add_u32 m0, s32, 31744
    s_add_u32 s33, s47, 37056
    buffer_load_dwordx4 v10, s[24:27], s33 offen lds
    v_mfma_f32_16x16x32_bf16 a[156:159], v[92:95], v[48:51], a[156:159]
    ds_read_b128 v[80:83], v14 offset:21504
    s_add_u32 m0, s32, 32768
    s_nop 0
    buffer_load_dwordx4 v11, s[24:27], s33 offen lds
    v_mfma_f32_16x16x32_bf16 a[160:163], v[92:95], v[52:55], a[160:163]
    ds_read_b128 v[84:87], v14 offset:25600
    s_add_u32 m0, s32, 33792
    s_nop 0
    buffer_load_dwordx4 v12, s[24:27], s33 offen lds
    v_mfma_f32_16x16x32_bf16 a[164:167], v[92:95], v[56:59], a[164:167]
    s_waitcnt lgkmcnt(9)
    v_mfma_f32_16x16x32_bf16 a[168:171], v[96:99], v[32:35], a[168:171]
    v_mfma_f32_16x16x32_bf16 a[172:175], v[96:99], v[36:39], a[172:175]
    ds_read_b64_tr_b16 v[88:89], v13 offset:6208
    v_mfma_f32_16x16x32_bf16 a[176:179], v[96:99], v[40:43], a[176:179]
    ds_read_b64_tr_b16 v[90:91], v13 offset:7744
    v_mfma_f32_16x16x32_bf16 a[180:183], v[96:99], v[44:47], a[180:183]
    v_mfma_f32_16x16x32_bf16 a[184:187], v[96:99], v[48:51], a[184:187]
    v_mfma_f32_16x16x32_bf16 a[188:191], v[96:99], v[52:55], a[188:191]
    v_mfma_f32_16x16x32_bf16 a[192:195], v[96:99], v[56:59], a[192:195]
    s_waitcnt lgkmcnt(5)
    v_mfma_f32_16x16x32_bf16 a[196:199], v[100:103], v[32:35], a[196:199]
    s_waitcnt vmcnt(6)
    v_mfma_f32_16x16x32_bf16 a[200:203], v[100:103], v[36:39], a[200:203]
    ds_read_b64_tr_b16 v[92:93], v13 offset:9216
    v_mfma_f32_16x16x32_bf16 a[204:207], v[100:103], v[40:43], a[204:207]
    ds_read_b64_tr_b16 v[94:95], v13 offset:10752
    v_mfma_f32_16x16x32_bf16 a[208:211], v[100:103], v[44:47], a[208:211]
    v_mfma_f32_16x16x32_bf16 a[212:215], v[100:103], v[48:51], a[212:215]
    v_mfma_f32_16x16x32_bf16 a[216:219], v[100:103], v[52:55], a[216:219]
    v_mfma_f32_16x16x32_bf16 a[220:223], v[100:103], v[56:59], a[220:223]
    s_waitcnt lgkmcnt(2)
    v_mfma_f32_16x16x32_bf16 a[224:227], v[88:91], v[32:35], a[224:227]
    v_mfma_f32_16x16x32_bf16 a[228:231], v[88:91], v[36:39], a[228:231]
    ds_read_b64_tr_b16 v[96:97], v13 offset:9248
    v_mfma_f32_16x16x32_bf16 a[232:235], v[88:91], v[40:43], a[232:235]
    ds_read_b64_tr_b16 v[98:99], v13 offset:10784
    v_mfma_f32_16x16x32_bf16 a[236:239], v[88:91], v[44:47], a[236:239]
    s_add_u32 m0, s32, 34816
    s_add_u32 s33, s47, 73728
    buffer_load_dwordx4 v10, s[24:27], s33 offen lds
    v_mfma_f32_16x16x32_bf16 a[240:243], v[88:91], v[48:51], a[240:243]
    s_add_u32 m0, s32, 35840
    s_nop 0
    buffer_load_dwordx4 v11, s[24:27], s33 offen lds
    v_mfma_f32_16x16x32_bf16 a[244:247], v[88:91], v[52:55], a[244:247]
    s_add_u32 m0, s32, 36864
    s_nop 0
    buffer_load_dwordx4 v12, s[24:27], s33 offen lds
    v_mfma_f32_16x16x32_bf16 a[248:251], v[88:91], v[56:59], a[248:251]
    s_waitcnt lgkmcnt(2)
    v_mfma_f32_16x16x32_bf16 a[0:3], v[92:95], v[60:63], a[0:3]
    v_mfma_f32_16x16x32_bf16 a[4:7], v[92:95], v[64:67], a[4:7]
    ds_read_b64_tr_b16 v[100:101], v13 offset:9280
    v_mfma_f32_16x16x32_bf16 a[8:11], v[92:95], v[68:71], a[8:11]
    ds_read_b64_tr_b16 v[102:103], v13 offset:10816
    v_mfma_f32_16x16x32_bf16 a[12:15], v[92:95], v[72:75], a[12:15]
    v_mfma_f32_16x16x32_bf16 a[16:19], v[92:95], v[76:79], a[16:19]
    v_mfma_f32_16x16x32_bf16 a[20:23], v[92:95], v[80:83], a[20:23]
    v_mfma_f32_16x16x32_bf16 a[24:27], v[92:95], v[84:87], a[24:27]
    s_waitcnt lgkmcnt(2)
    v_mfma_f32_16x16x32_bf16 a[28:31], v[96:99], v[60:63], a[28:31]
    s_waitcnt vmcnt(6)
    v_mfma_f32_16x16x32_bf16 a[32:35], v[96:99], v[64:67], a[32:35]
    ds_read_b64_tr_b16 v[88:89], v13 offset:0
    v_mfma_f32_16x16x32_bf16 a[36:39], v[96:99], v[68:71], a[36:39]
    ds_read_b64_tr_b16 v[90:91], v13 offset:1536
    v_mfma_f32_16x16x32_bf16 a[40:43], v[96:99], v[72:75], a[40:43]
    v_mfma_f32_16x16x32_bf16 a[44:47], v[96:99], v[76:79], a[44:47]
    v_mfma_f32_16x16x32_bf16 a[48:51], v[96:99], v[80:83], a[48:51]
    v_mfma_f32_16x16x32_bf16 a[52:55], v[96:99], v[84:87], a[52:55]
    s_waitcnt lgkmcnt(2)
    v_mfma_f32_16x16x32_bf16 a[56:59], v[100:103], v[60:63], a[56:59]
    v_mfma_f32_16x16x32_bf16 a[60:63], v[100:103], v[64:67], a[60:63]
    ds_read_b64_tr_b16 v[92:93], v13 offset:32
    v_mfma_f32_16x16x32_bf16 a[64:67], v[100:103], v[68:71], a[64:67]
    ds_read_b64_tr_b16 v[94:95], v13 offset:1568
    v_mfma_f32_16x16x32_bf16 a[68:71], v[100:103], v[72:75], a[68:71]
    s_add_u32 m0, s32, 37888
    s_add_u32 s33, s47, 73824
    buffer_load_dwordx4 v10, s[24:27], s33 offen lds
    v_mfma_f32_16x16x32_bf16 a[72:75], v[100:103], v[76:79], a[72:75]
    s_add_u32 m0, s32, 38912
    s_nop 0
    buffer_load_dwordx4 v11, s[24:27], s33 offen lds
    v_mfma_f32_16x16x32_bf16 a[76:79], v[100:103], v[80:83], a[76:79]
    s_add_u32 m0, s32, 39936
    s_nop 0
    buffer_load_dwordx4 v12, s[24:27], s33 offen lds
    v_mfma_f32_16x16x32_bf16 a[80:83], v[100:103], v[84:87], a[80:83]
    s_waitcnt lgkmcnt(2)
    v_mfma_f32_16x16x32_bf16 a[84:87], v[88:91], v[60:63], a[84:87]
    v_mfma_f32_16x16x32_bf16 a[88:91], v[88:91], v[64:67], a[88:91]
    ds_read_b64_tr_b16 v[96:97], v13 offset:64
    v_mfma_f32_16x16x32_bf16 a[92:95], v[88:91], v[68:71], a[92:95]
    ds_read_b64_tr_b16 v[98:99], v13 offset:1600
    v_mfma_f32_16x16x32_bf16 a[96:99], v[88:91], v[72:75], a[96:99]
    v_mfma_f32_16x16x32_bf16 a[100:103], v[88:91], v[76:79], a[100:103]
    v_mfma_f32_16x16x32_bf16 a[104:107], v[88:91], v[80:83], a[104:107]
    v_mfma_f32_16x16x32_bf16 a[108:111], v[88:91], v[84:87], a[108:111]
    s_waitcnt lgkmcnt(2)
    v_mfma_f32_16x16x32_bf16 a[112:115], v[92:95], v[60:63], a[112:115]
    s_waitcnt vmcnt(6)
    v_mfma_f32_16x16x32_bf16 a[116:119], v[92:95], v[64:67], a[116:119]
    ds_read_b64_tr_b16 v[100:101], v13 offset:3072
    v_mfma_f32_16x16x32_bf16 a[120:123], v[92:95], v[68:71], a[120:123]
    ds_read_b64_tr_b16 v[102:103], v13 offset:4608
    v_mfma_f32_16x16x32_bf16 a[124:127], v[92:95], v[72:75], a[124:127]
    ds_read_b128 v[32:35], v14 offset:2048
    v_mfma_f32_16x16x32_bf16 a[128:131], v[92:95], v[76:79], a[128:131]
    ds_read_b128 v[36:39], v14 offset:6144
    v_mfma_f32_16x16x32_bf16 a[132:135], v[92:95], v[80:83], a[132:135]
    ds_read_b128 v[40:43], v14 offset:10240
    v_mfma_f32_16x16x32_bf16 a[136:139], v[92:95], v[84:87], a[136:139]
    s_waitcnt lgkmcnt(5)
    ds_read_b128 v[44:47], v14 offset:14336
    v_mfma_f32_16x16x32_bf16 a[140:143], v[96:99], v[60:63], a[140:143]
    v_mfma_f32_16x16x32_bf16 a[144:147], v[96:99], v[64:67], a[144:147]
    ds_read_b64_tr_b16 v[88:89], v13 offset:3104
    v_mfma_f32_16x16x32_bf16 a[148:151], v[96:99], v[68:71], a[148:151]
    ds_read_b64_tr_b16 v[90:91], v13 offset:4640
    v_mfma_f32_16x16x32_bf16 a[152:155], v[96:99], v[72:75], a[152:155]
    ds_read_b128 v[48:51], v14 offset:18432
    s_add_u32 m0, s32, 28672
    s_add_u32 s33, s47, 73920
    buffer_load_dwordx4 v10, s[24:27], s33 offen lds
    v_mfma_f32_16x16x32_bf16 a[156:159], v[96:99], v[76:79], a[156:159]
    ds_read_b128 v[52:55], v14 offset:22528
    s_add_u32 m0, s32, 29696
    s_nop 0
    buffer_load_dwordx4 v11, s[24:27], s33 offen lds
    v_mfma_f32_16x16x32_bf16 a[160:163], v[96:99], v[80:83], a[160:163]
    ds_read_b128 v[56:59], v14 offset:26624
    s_add_u32 m0, s32, 30720
    s_nop 0
    buffer_load_dwordx4 v12, s[24:27], s33 offen lds
    v_mfma_f32_16x16x32_bf16 a[164:167], v[96:99], v[84:87], a[164:167]
    s_waitcnt lgkmcnt(9)
    v_mfma_f32_16x16x32_bf16 a[168:171], v[100:103], v[60:63], a[168:171]
    v_mfma_f32_16x16x32_bf16 a[172:175], v[100:103], v[64:67], a[172:175]
    ds_read_b64_tr_b16 v[92:93], v13 offset:3136
    v_mfma_f32_16x16x32_bf16 a[176:179], v[100:103], v[68:71], a[176:179]
    ds_read_b64_tr_b16 v[94:95], v13 offset:4672
    v_mfma_f32_16x16x32_bf16 a[180:183], v[100:103], v[72:75], a[180:183]
    v_mfma_f32_16x16x32_bf16 a[184:187], v[100:103], v[76:79], a[184:187]
    v_mfma_f32_16x16x32_bf16 a[188:191], v[100:103], v[80:83], a[188:191]
    v_mfma_f32_16x16x32_bf16 a[192:195], v[100:103], v[84:87], a[192:195]
    s_waitcnt lgkmcnt(5)
    v_mfma_f32_16x16x32_bf16 a[196:199], v[88:91], v[60:63], a[196:199]
    s_waitcnt vmcnt(6)
    v_mfma_f32_16x16x32_bf16 a[200:203], v[88:91], v[64:67], a[200:203]
    ds_read_b64_tr_b16 v[96:97], v13 offset:6144
    v_mfma_f32_16x16x32_bf16 a[204:207], v[88:91], v[68:71], a[204:207]
    ds_read_b64_tr_b16 v[98:99], v13 offset:7680
    v_mfma_f32_16x16x32_bf16 a[208:211], v[88:91], v[72:75], a[208:211]
    v_mfma_f32_16x16x32_bf16 a[212:215], v[88:91], v[76:79], a[212:215]
    v_mfma_f32_16x16x32_bf16 a[216:219], v[88:91], v[80:83], a[216:219]
    v_mfma_f32_16x16x32_bf16 a[220:223], v[88:91], v[84:87], a[220:223]
    s_waitcnt lgkmcnt(2)
    v_mfma_f32_16x16x32_bf16 a[224:227], v[92:95], v[60:63], a[224:227]
    v_mfma_f32_16x16x32_bf16 a[228:231], v[92:95], v[64:67], a[228:231]
    ds_read_b64_tr_b16 v[100:101], v13 offset:6176
    v_mfma_f32_16x16x32_bf16 a[232:235], v[92:95], v[68:71], a[232:235]
    ds_read_b64_tr_b16 v[102:103], v13 offset:7712
    v_mfma_f32_16x16x32_bf16 a[236:239], v[92:95], v[72:75], a[236:239]
    s_add_u32 m0, s32, 31744
    s_add_u32 s33, s47, 110592
    buffer_load_dwordx4 v10, s[24:27], s33 offen lds
    v_mfma_f32_16x16x32_bf16 a[240:243], v[92:95], v[76:79], a[240:243]
    s_add_u32 m0, s32, 32768
    s_nop 0
    buffer_load_dwordx4 v11, s[24:27], s33 offen lds
    v_mfma_f32_16x16x32_bf16 a[244:247], v[92:95], v[80:83], a[244:247]
    s_add_u32 m0, s32, 33792
    s_nop 0
    buffer_load_dwordx4 v12, s[24:27], s33 offen lds
    v_mfma_f32_16x16x32_bf16 a[248:251], v[92:95], v[84:87], a[248:251]
    s_waitcnt lgkmcnt(2)
    v_mfma_f32_16x16x32_bf16 a[0:3], v[96:99], v[32:35], a[0:3]
    v_mfma_f32_16x16x32_bf16 a[4:7], v[96:99], v[36:39], a[4:7]
    ds_read_b64_tr_b16 v[88:89], v13 offset:6208
    v_mfma_f32_16x16x32_bf16 a[8:11], v[96:99], v[40:43], a[8:11]
    ds_read_b64_tr_b16 v[90:91], v13 offset:7744
    v_mfma_f32_16x16x32_bf16 a[12:15], v[96:99], v[44:47], a[12:15]
    v_mfma_f32_16x16x32_bf16 a[16:19], v[96:99], v[48:51], a[16:19]
    v_mfma_f32_16x16x32_bf16 a[20:23], v[96:99], v[52:55], a[20:23]
    v_mfma_f32_16x16x32_bf16 a[24:27], v[96:99], v[56:59], a[24:27]
    s_waitcnt lgkmcnt(2)
    v_mfma_f32_16x16x32_bf16 a[28:31], v[100:103], v[32:35], a[28:31]
    s_waitcnt vmcnt(6)
    v_mfma_f32_16x16x32_bf16 a[32:35], v[100:103], v[36:39], a[32:35]
    ds_read_b64_tr_b16 v[92:93], v13 offset:9216
    v_mfma_f32_16x16x32_bf16 a[36:39], v[100:103], v[40:43], a[36:39]
    ds_read_b64_tr_b16 v[94:95], v13 offset:10752
    v_mfma_f32_16x16x32_bf16 a[40:43], v[100:103], v[44:47], a[40:43]
    v_mfma_f32_16x16x32_bf16 a[44:47], v[100:103], v[48:51], a[44:47]
    v_mfma_f32_16x16x32_bf16 a[48:51], v[100:103], v[52:55], a[48:51]
    v_mfma_f32_16x16x32_bf16 a[52:55], v[100:103], v[56:59], a[52:55]
    s_waitcnt lgkmcnt(2)
    v_mfma_f32_16x16x32_bf16 a[56:59], v[88:91], v[32:35], a[56:59]
    v_mfma_f32_16x16x32_bf16 a[60:63], v[88:91], v[36:39], a[60:63]
    ds_read_b64_tr_b16 v[96:97], v13 offset:9248
    v_mfma_f32_16x16x32_bf16 a[64:67], v[88:91], v[40:43], a[64:67]
    ds_read_b64_tr_b16 v[98:99], v13 offset:10784
    v_mfma_f32_16x16x32_bf16 a[68:71], v[88:91], v[44:47], a[68:71]
    s_add_u32 m0, s32, 34816
    s_add_u32 s33, s47, 110688
    buffer_load_dwordx4 v10, s[24:27], s33 offen lds
    v_mfma_f32_16x16x32_bf16 a[72:75], v[88:91], v[48:51], a[72:75]
    s_add_u32 m0, s32, 35840
    s_nop 0
    buffer_load_dwordx4 v11, s[24:27], s33 offen lds
    v_mfma_f32_16x16x32_bf16 a[76:79], v[88:91], v[52:55], a[76:79]
    s_add_u32 m0, s32, 36864
    s_nop 0
    buffer_load_dwordx4 v12, s[24:27], s33 offen lds
    v_mfma_f32_16x16x32_bf16 a[80:83], v[88:91], v[56:59], a[80:83]
    s_waitcnt lgkmcnt(2)
    v_mfma_f32_16x16x32_bf16 a[84:87], v[92:95], v[32:35], a[84:87]
    v_mfma_f32_16x16x32_bf16 a[88:91], v[92:95], v[36:39], a[88:91]
    ds_read_b64_tr_b16 v[100:101], v13 offset:9280
    v_mfma_f32_16x16x32_bf16 a[92:95], v[92:95], v[40:43], a[92:95]
    ds_read_b64_tr_b16 v[102:103], v13 offset:10816
    v_mfma_f32_16x16x32_bf16 a[96:99], v[92:95], v[44:47], a[96:99]
    v_mfma_f32_16x16x32_bf16 a[100:103], v[92:95], v[48:51], a[100:103]
    v_mfma_f32_16x16x32_bf16 a[104:107], v[92:95], v[52:55], a[104:107]
    v_mfma_f32_16x16x32_bf16 a[108:111], v[92:95], v[56:59], a[108:111]
    s_waitcnt lgkmcnt(2)
    v_mfma_f32_16x16x32_bf16 a[112:115], v[96:99], v[32:35], a[112:115]
    s_waitcnt vmcnt(6)
    v_mfma_f32_16x16x32_bf16 a[116:119], v[96:99], v[36:39], a[116:119]
    ds_read_b64_tr_b16 v[88:89], v13 offset:0
    v_mfma_f32_16x16x32_bf16 a[120:123], v[96:99], v[40:43], a[120:123]
    ds_read_b64_tr_b16 v[90:91], v13 offset:1536
    v_mfma_f32_16x16x32_bf16 a[124:127], v[96:99], v[44:47], a[124:127]
    ds_read_b128 v[60:63], v14 offset:3072
    v_mfma_f32_16x16x32_bf16 a[128:131], v[96:99], v[48:51], a[128:131]
    ds_read_b128 v[64:67], v14 offset:7168
    v_mfma_f32_16x16x32_bf16 a[132:135], v[96:99], v[52:55], a[132:135]
    ds_read_b128 v[68:71], v14 offset:11264
    v_mfma_f32_16x16x32_bf16 a[136:139], v[96:99], v[56:59], a[136:139]
    s_waitcnt lgkmcnt(5)
    ds_read_b128 v[72:75], v14 offset:15360
    v_mfma_f32_16x16x32_bf16 a[140:143], v[100:103], v[32:35], a[140:143]
    v_mfma_f32_16x16x32_bf16 a[144:147], v[100:103], v[36:39], a[144:147]
    ds_read_b64_tr_b16 v[92:93], v13 offset:32
    v_mfma_f32_16x16x32_bf16 a[148:151], v[100:103], v[40:43], a[148:151]
    ds_read_b64_tr_b16 v[94:95], v13 offset:1568
    v_mfma_f32_16x16x32_bf16 a[152:155], v[100:103], v[44:47], a[152:155]
    ds_read_b128 v[76:79], v14 offset:19456
    s_add_u32 m0, s32, 37888
    s_add_u32 s33, s47, 110784
    buffer_load_dwordx4 v10, s[24:27], s33 offen lds
    v_mfma_f32_16x16x32_bf16 a[156:159], v[100:103], v[48:51], a[156:159]
    ds_read_b128 v[80:83], v14 offset:23552
    s_add_u32 m0, s32, 38912
    s_nop 0
    buffer_load_dwordx4 v11, s[24:27], s33 offen lds
    v_mfma_f32_16x16x32_bf16 a[160:163], v[100:103], v[52:55], a[160:163]
    ds_read_b128 v[84:87], v14 offset:27648
    s_add_u32 m0, s32, 39936
    s_nop 0
    buffer_load_dwordx4 v12, s[24:27], s33 offen lds
    v_mfma_f32_16x16x32_bf16 a[164:167], v[100:103], v[56:59], a[164:167]
    s_waitcnt lgkmcnt(9)
    v_mfma_f32_16x16x32_bf16 a[168:171], v[88:91], v[32:35], a[168:171]
    v_mfma_f32_16x16x32_bf16 a[172:175], v[88:91], v[36:39], a[172:175]
    ds_read_b64_tr_b16 v[96:97], v13 offset:64
    v_mfma_f32_16x16x32_bf16 a[176:179], v[88:91], v[40:43], a[176:179]
    ds_read_b64_tr_b16 v[98:99], v13 offset:1600
    v_mfma_f32_16x16x32_bf16 a[180:183], v[88:91], v[44:47], a[180:183]
    v_mfma_f32_16x16x32_bf16 a[184:187], v[88:91], v[48:51], a[184:187]
    v_mfma_f32_16x16x32_bf16 a[188:191], v[88:91], v[52:55], a[188:191]
    v_mfma_f32_16x16x32_bf16 a[192:195], v[88:91], v[56:59], a[192:195]
    s_waitcnt lgkmcnt(5)
    v_mfma_f32_16x16x32_bf16 a[196:199], v[92:95], v[32:35], a[196:199]
    s_waitcnt vmcnt(6)
    v_mfma_f32_16x16x32_bf16 a[200:203], v[92:95], v[36:39], a[200:203]
    ds_read_b64_tr_b16 v[100:101], v13 offset:3072
    v_mfma_f32_16x16x32_bf16 a[204:207], v[92:95], v[40:43], a[204:207]
    ds_read_b64_tr_b16 v[102:103], v13 offset:4608
    v_mfma_f32_16x16x32_bf16 a[208:211], v[92:95], v[44:47], a[208:211]
    v_mfma_f32_16x16x32_bf16 a[212:215], v[92:95], v[48:51], a[212:215]
    v_mfma_f32_16x16x32_bf16 a[216:219], v[92:95], v[52:55], a[216:219]
    v_mfma_f32_16x16x32_bf16 a[220:223], v[92:95], v[56:59], a[220:223]
    s_waitcnt lgkmcnt(2)
    v_mfma_f32_16x16x32_bf16 a[224:227], v[96:99], v[32:35], a[224:227]
    v_mfma_f32_16x16x32_bf16 a[228:231], v[96:99], v[36:39], a[228:231]
    ds_read_b64_tr_b16 v[88:89], v13 offset:3104
    v_mfma_f32_16x16x32_bf16 a[232:235], v[96:99], v[40:43], a[232:235]
    ds_read_b64_tr_b16 v[90:91], v13 offset:4640
    v_mfma_f32_16x16x32_bf16 a[236:239], v[96:99], v[44:47], a[236:239]
    v_mfma_f32_16x16x32_bf16 a[240:243], v[96:99], v[48:51], a[240:243]
    v_mfma_f32_16x16x32_bf16 a[244:247], v[96:99], v[52:55], a[244:247]
    v_mfma_f32_16x16x32_bf16 a[248:251], v[96:99], v[56:59], a[248:251]
    s_waitcnt lgkmcnt(2)
    v_mfma_f32_16x16x32_bf16 a[0:3], v[100:103], v[60:63], a[0:3]
    v_mfma_f32_16x16x32_bf16 a[4:7], v[100:103], v[64:67], a[4:7]
    ds_read_b64_tr_b16 v[92:93], v13 offset:3136
    v_mfma_f32_16x16x32_bf16 a[8:11], v[100:103], v[68:71], a[8:11]
    ds_read_b64_tr_b16 v[94:95], v13 offset:4672
    v_mfma_f32_16x16x32_bf16 a[12:15], v[100:103], v[72:75], a[12:15]
    v_mfma_f32_16x16x32_bf16 a[16:19], v[100:103], v[76:79], a[16:19]
    v_accvgpr_read_b32 v104, a0
    v_accvgpr_read_b32 v105, a1
    v_mfma_f32_16x16x32_bf16 a[20:23], v[100:103], v[80:83], a[20:23]
    v_accvgpr_read_b32 v106, a2
    v_accvgpr_read_b32 v107, a3
    v_mfma_f32_16x16x32_bf16 a[24:27], v[100:103], v[84:87], a[24:27]
    s_waitcnt lgkmcnt(2)
    v_accvgpr_read_b32 v108, a4
    v_accvgpr_read_b32 v109, a5
    v_mfma_f32_16x16x32_bf16 a[28:31], v[88:91], v[60:63], a[28:31]
    s_waitcnt vmcnt(3)
    v_accvgpr_read_b32 v110, a6
    v_accvgpr_read_b32 v111, a7
    v_mfma_f32_16x16x32_bf16 a[32:35], v[88:91], v[64:67], a[32:35]
    ds_read_b64_tr_b16 v[96:97], v13 offset:6144
    v_cvt_pk_bf16_f32 v112, v104, v105
    v_cvt_pk_bf16_f32 v113, v106, v107
    v_mfma_f32_16x16x32_bf16 a[36:39], v[88:91], v[68:71], a[36:39]
    ds_read_b64_tr_b16 v[98:99], v13 offset:7680
    v_cvt_pk_bf16_f32 v114, v108, v109
    v_cvt_pk_bf16_f32 v115, v110, v111
    v_mfma_f32_16x16x32_bf16 a[40:43], v[88:91], v[72:75], a[40:43]
    s_mov_b32 s34, 0
    buffer_store_dwordx4 v[112:115], v1, s[28:31], s34 offen offset:0 sc1
    v_mfma_f32_16x16x32_bf16 a[44:47], v[88:91], v[76:79], a[44:47]
    v_accvgpr_read_b32 v120, a8
    v_accvgpr_read_b32 v121, a9
    v_mfma_f32_16x16x32_bf16 a[48:51], v[88:91], v[80:83], a[48:51]
    v_accvgpr_read_b32 v122, a10
    v_accvgpr_read_b32 v123, a11
    v_mfma_f32_16x16x32_bf16 a[52:55], v[88:91], v[84:87], a[52:55]
    s_waitcnt lgkmcnt(2)
    v_accvgpr_read_b32 v124, a12
    v_accvgpr_read_b32 v125, a13
    v_mfma_f32_16x16x32_bf16 a[56:59], v[92:95], v[60:63], a[56:59]
    v_accvgpr_read_b32 v126, a14
    v_accvgpr_read_b32 v127, a15
    v_mfma_f32_16x16x32_bf16 a[60:63], v[92:95], v[64:67], a[60:63]
    ds_read_b64_tr_b16 v[100:101], v13 offset:6176
    v_cvt_pk_bf16_f32 v128, v120, v121
    v_cvt_pk_bf16_f32 v129, v122, v123
    v_mfma_f32_16x16x32_bf16 a[64:67], v[92:95], v[68:71], a[64:67]
    ds_read_b64_tr_b16 v[102:103], v13 offset:7712
    v_cvt_pk_bf16_f32 v130, v124, v125
    v_cvt_pk_bf16_f32 v131, v126, v127
    v_mfma_f32_16x16x32_bf16 a[68:71], v[92:95], v[72:75], a[68:71]
    s_mov_b32 s34, 0
    buffer_store_dwordx4 v[128:131], v1, s[28:31], s34 offen offset:1024 sc1
    v_mfma_f32_16x16x32_bf16 a[72:75], v[92:95], v[76:79], a[72:75]
    v_accvgpr_read_b32 v136, a16
    v_accvgpr_read_b32 v137, a17
    v_mfma_f32_16x16x32_bf16 a[76:79], v[92:95], v[80:83], a[76:79]
    v_accvgpr_read_b32 v138, a18
    v_accvgpr_read_b32 v139, a19
    v_mfma_f32_16x16x32_bf16 a[80:83], v[92:95], v[84:87], a[80:83]
    s_waitcnt lgkmcnt(2)
    v_accvgpr_read_b32 v140, a20
    v_accvgpr_read_b32 v141, a21
    v_mfma_f32_16x16x32_bf16 a[84:87], v[96:99], v[60:63], a[84:87]
    v_accvgpr_read_b32 v142, a22
    v_accvgpr_read_b32 v143, a23
    v_mfma_f32_16x16x32_bf16 a[88:91], v[96:99], v[64:67], a[88:91]
    ds_read_b64_tr_b16 v[88:89], v13 offset:6208
    v_cvt_pk_bf16_f32 v144, v136, v137
    v_cvt_pk_bf16_f32 v145, v138, v139
    v_mfma_f32_16x16x32_bf16 a[92:95], v[96:99], v[68:71], a[92:95]
    ds_read_b64_tr_b16 v[90:91], v13 offset:7744
    v_cvt_pk_bf16_f32 v146, v140, v141
    v_cvt_pk_bf16_f32 v147, v142, v143
    v_mfma_f32_16x16x32_bf16 a[96:99], v[96:99], v[72:75], a[96:99]
    s_mov_b32 s34, 0
    buffer_store_dwordx4 v[144:147], v1, s[28:31], s34 offen offset:2048 sc1
    v_mfma_f32_16x16x32_bf16 a[100:103], v[96:99], v[76:79], a[100:103]
    v_accvgpr_read_b32 v152, a24
    v_accvgpr_read_b32 v153, a25
    v_mfma_f32_16x16x32_bf16 a[104:107], v[96:99], v[80:83], a[104:107]
    v_accvgpr_read_b32 v154, a26
    v_accvgpr_read_b32 v155, a27
    v_mfma_f32_16x16x32_bf16 a[108:111], v[96:99], v[84:87], a[108:111]
    s_waitcnt lgkmcnt(2)
    v_accvgpr_read_b32 v156, a28
    v_accvgpr_read_b32 v157, a29
    v_mfma_f32_16x16x32_bf16 a[112:115], v[100:103], v[60:63], a[112:115]
    s_waitcnt vmcnt(0)
    v_accvgpr_read_b32 v158, a30
    v_accvgpr_read_b32 v159, a31
    v_mfma_f32_16x16x32_bf16 a[116:119], v[100:103], v[64:67], a[116:119]
    ds_read_b64_tr_b16 v[92:93], v13 offset:9216
    v_cvt_pk_bf16_f32 v160, v152, v153
    v_cvt_pk_bf16_f32 v161, v154, v155
    v_mfma_f32_16x16x32_bf16 a[120:123], v[100:103], v[68:71], a[120:123]
    ds_read_b64_tr_b16 v[94:95], v13 offset:10752
    v_cvt_pk_bf16_f32 v162, v156, v157
    v_cvt_pk_bf16_f32 v163, v158, v159
    v_mfma_f32_16x16x32_bf16 a[124:127], v[100:103], v[72:75], a[124:127]
    s_mov_b32 s34, 0
    buffer_store_dwordx4 v[160:163], v1, s[28:31], s34 offen offset:3072 sc1
    v_mfma_f32_16x16x32_bf16 a[128:131], v[100:103], v[76:79], a[128:131]
    v_accvgpr_read_b32 v104, a32
    v_accvgpr_read_b32 v105, a33
    v_mfma_f32_16x16x32_bf16 a[132:135], v[100:103], v[80:83], a[132:135]
    v_accvgpr_read_b32 v106, a34
    v_accvgpr_read_b32 v107, a35
    v_mfma_f32_16x16x32_bf16 a[136:139], v[100:103], v[84:87], a[136:139]
    s_waitcnt lgkmcnt(2)
    v_accvgpr_read_b32 v108, a36
    v_accvgpr_read_b32 v109, a37
    v_mfma_f32_16x16x32_bf16 a[140:143], v[88:91], v[60:63], a[140:143]
    v_accvgpr_read_b32 v110, a38
    v_accvgpr_read_b32 v111, a39
    v_mfma_f32_16x16x32_bf16 a[144:147], v[88:91], v[64:67], a[144:147]
    ds_read_b64_tr_b16 v[96:97], v13 offset:9248
    v_cvt_pk_bf16_f32 v112, v104, v105
    v_cvt_pk_bf16_f32 v113, v106, v107
    v_mfma_f32_16x16x32_bf16 a[148:151], v[88:91], v[68:71], a[148:151]
    ds_read_b64_tr_b16 v[98:99], v13 offset:10784
    v_cvt_pk_bf16_f32 v114, v108, v109
    v_cvt_pk_bf16_f32 v115, v110, v111
    v_mfma_f32_16x16x32_bf16 a[152:155], v[88:91], v[72:75], a[152:155]
    s_mov_b32 s34, 4096
    buffer_store_dwordx4 v[112:115], v1, s[28:31], s34 offen offset:0 sc1
    v_mfma_f32_16x16x32_bf16 a[156:159], v[88:91], v[76:79], a[156:159]
    v_accvgpr_read_b32 v120, a40
    v_accvgpr_read_b32 v121, a41
    v_mfma_f32_16x16x32_bf16 a[160:163], v[88:91], v[80:83], a[160:163]
    v_accvgpr_read_b32 v122, a42
    v_accvgpr_read_b32 v123, a43
    v_mfma_f32_16x16x32_bf16 a[164:167], v[88:91], v[84:87], a[164:167]
    s_waitcnt lgkmcnt(2)
    v_accvgpr_read_b32 v124, a44
    v_accvgpr_read_b32 v125, a45
    v_mfma_f32_16x16x32_bf16 a[168:171], v[92:95], v[60:63], a[168:171]
    v_accvgpr_read_b32 v126, a46
    v_accvgpr_read_b32 v127, a47
    v_mfma_f32_16x16x32_bf16 a[172:175], v[92:95], v[64:67], a[172:175]
    ds_read_b64_tr_b16 v[100:101], v13 offset:9280
    v_cvt_pk_bf16_f32 v128, v120, v121
    v_cvt_pk_bf16_f32 v129, v122, v123
    v_mfma_f32_16x16x32_bf16 a[176:179], v[92:95], v[68:71], a[176:179]
    ds_read_b64_tr_b16 v[102:103], v13 offset:10816
    v_cvt_pk_bf16_f32 v130, v124, v125
    v_cvt_pk_bf16_f32 v131, v126, v127
    v_mfma_f32_16x16x32_bf16 a[180:183], v[92:95], v[72:75], a[180:183]
    s_mov_b32 s34, 4096
    buffer_store_dwordx4 v[128:131], v1, s[28:31], s34 offen offset:1024 sc1
    v_mfma_f32_16x16x32_bf16 a[184:187], v[92:95], v[76:79], a[184:187]
    v_accvgpr_read_b32 v136, a48
    v_accvgpr_read_b32 v137, a49
    v_mfma_f32_16x16x32_bf16 a[188:191], v[92:95], v[80:83], a[188:191]
    v_accvgpr_read_b32 v138, a50
    v_accvgpr_read_b32 v139, a51
    v_mfma_f32_16x16x32_bf16 a[192:195], v[92:95], v[84:87], a[192:195]
    s_waitcnt lgkmcnt(2)
    v_accvgpr_read_b32 v140, a52
    v_accvgpr_read_b32 v141, a53
    v_mfma_f32_16x16x32_bf16 a[196:199], v[96:99], v[60:63], a[196:199]
    v_accvgpr_read_b32 v142, a54
    v_accvgpr_read_b32 v143, a55
    v_mfma_f32_16x16x32_bf16 a[200:203], v[96:99], v[64:67], a[200:203]
    v_cvt_pk_bf16_f32 v144, v136, v137
    v_cvt_pk_bf16_f32 v145, v138, v139
    v_mfma_f32_16x16x32_bf16 a[204:207], v[96:99], v[68:71], a[204:207]
    v_cvt_pk_bf16_f32 v146, v140, v141
    v_cvt_pk_bf16_f32 v147, v142, v143
    v_mfma_f32_16x16x32_bf16 a[208:211], v[96:99], v[72:75], a[208:211]
    s_mov_b32 s34, 4096
    buffer_store_dwordx4 v[144:147], v1, s[28:31], s34 offen offset:2048 sc1
    v_mfma_f32_16x16x32_bf16 a[212:215], v[96:99], v[76:79], a[212:215]
    v_accvgpr_read_b32 v152, a56
    v_accvgpr_read_b32 v153, a57
    v_mfma_f32_16x16x32_bf16 a[216:219], v[96:99], v[80:83], a[216:219]
    v_accvgpr_read_b32 v154, a58
    v_accvgpr_read_b32 v155, a59
    v_mfma_f32_16x16x32_bf16 a[220:223], v[96:99], v[84:87], a[220:223]
    s_waitcnt lgkmcnt(0)
    v_accvgpr_read_b32 v156, a60
    v_accvgpr_read_b32 v157, a61
    v_mfma_f32_16x16x32_bf16 a[224:227], v[100:103], v[60:63], a[224:227]
    v_accvgpr_read_b32 v158, a62
    v_accvgpr_read_b32 v159, a63
    v_mfma_f32_16x16x32_bf16 a[228:231], v[100:103], v[64:67], a[228:231]
    v_cvt_pk_bf16_f32 v160, v152, v153
    v_cvt_pk_bf16_f32 v161, v154, v155
    v_mfma_f32_16x16x32_bf16 a[232:235], v[100:103], v[68:71], a[232:235]
    v_cvt_pk_bf16_f32 v162, v156, v157
    v_cvt_pk_bf16_f32 v163, v158, v159
    v_mfma_f32_16x16x32_bf16 a[236:239], v[100:103], v[72:75], a[236:239]
    s_mov_b32 s34, 4096
    buffer_store_dwordx4 v[160:163], v1, s[28:31], s34 offen offset:3072 sc1
    v_mfma_f32_16x16x32_bf16 a[240:243], v[100:103], v[76:79], a[240:243]
    v_accvgpr_read_b32 v104, a64
    v_accvgpr_read_b32 v105, a65
    v_mfma_f32_16x16x32_bf16 a[244:247], v[100:103], v[80:83], a[244:247]
    v_accvgpr_read_b32 v106, a66
    v_accvgpr_read_b32 v107, a67
    v_mfma_f32_16x16x32_bf16 a[248:251], v[100:103], v[84:87], a[248:251]
    v_accvgpr_read_b32 v108, a68
    v_accvgpr_read_b32 v109, a69
    v_accvgpr_read_b32 v110, a70
    v_accvgpr_read_b32 v111, a71
    v_cvt_pk_bf16_f32 v112, v104, v105
    v_cvt_pk_bf16_f32 v113, v106, v107
    v_cvt_pk_bf16_f32 v114, v108, v109
    v_cvt_pk_bf16_f32 v115, v110, v111
    s_mov_b32 s34, 8192
    buffer_store_dwordx4 v[112:115], v1, s[28:31], s34 offen offset:0 sc1
    v_accvgpr_read_b32 v120, a72
    v_accvgpr_read_b32 v121, a73
    v_accvgpr_read_b32 v122, a74
    v_accvgpr_read_b32 v123, a75
    v_accvgpr_read_b32 v124, a76
    v_accvgpr_read_b32 v125, a77
    v_accvgpr_read_b32 v126, a78
    v_accvgpr_read_b32 v127, a79
    v_cvt_pk_bf16_f32 v128, v120, v121
    v_cvt_pk_bf16_f32 v129, v122, v123
    v_cvt_pk_bf16_f32 v130, v124, v125
    v_cvt_pk_bf16_f32 v131, v126, v127
    s_mov_b32 s34, 8192
    buffer_store_dwordx4 v[128:131], v1, s[28:31], s34 offen offset:1024 sc1
    v_accvgpr_read_b32 v136, a80
    v_accvgpr_read_b32 v137, a81
    v_accvgpr_read_b32 v138, a82
    v_accvgpr_read_b32 v139, a83
    v_accvgpr_read_b32 v140, a84
    v_accvgpr_read_b32 v141, a85
    v_accvgpr_read_b32 v142, a86
    v_accvgpr_read_b32 v143, a87
    v_cvt_pk_bf16_f32 v144, v136, v137
    v_cvt_pk_bf16_f32 v145, v138, v139
    v_cvt_pk_bf16_f32 v146, v140, v141
    v_cvt_pk_bf16_f32 v147, v142, v143
    s_mov_b32 s34, 8192
    buffer_store_dwordx4 v[144:147], v1, s[28:31], s34 offen offset:2048 sc1
    v_accvgpr_read_b32 v152, a88
    v_accvgpr_read_b32 v153, a89
    v_accvgpr_read_b32 v154, a90
    v_accvgpr_read_b32 v155, a91
    v_accvgpr_read_b32 v156, a92
    v_accvgpr_read_b32 v157, a93
    v_accvgpr_read_b32 v158, a94
    v_accvgpr_read_b32 v159, a95
    v_cvt_pk_bf16_f32 v160, v152, v153
    v_cvt_pk_bf16_f32 v161, v154, v155
    v_cvt_pk_bf16_f32 v162, v156, v157
    v_cvt_pk_bf16_f32 v163, v158, v159
    s_mov_b32 s34, 8192
    buffer_store_dwordx4 v[160:163], v1, s[28:31], s34 offen offset:3072 sc1
    v_accvgpr_read_b32 v104, a96
    v_accvgpr_read_b32 v105, a97
    v_accvgpr_read_b32 v106, a98
    v_accvgpr_read_b32 v107, a99
    v_accvgpr_read_b32 v108, a100
    v_accvgpr_read_b32 v109, a101
    v_accvgpr_read_b32 v110, a102
    v_accvgpr_read_b32 v111, a103
    v_cvt_pk_bf16_f32 v112, v104, v105
    v_cvt_pk_bf16_f32 v113, v106, v107
    v_cvt_pk_bf16_f32 v114, v108, v109
    v_cvt_pk_bf16_f32 v115, v110, v111
    s_mov_b32 s34, 12288
    buffer_store_dwordx4 v[112:115], v1, s[28:31], s34 offen offset:0 sc1
    v_accvgpr_read_b32 v120, a104
    v_accvgpr_read_b32 v121, a105
    v_accvgpr_read_b32 v122, a106
    v_accvgpr_read_b32 v123, a107
    v_accvgpr_read_b32 v124, a108
    v_accvgpr_read_b32 v125, a109
    v_accvgpr_read_b32 v126, a110
    v_accvgpr_read_b32 v127, a111
    v_cvt_pk_bf16_f32 v128, v120, v121
    v_cvt_pk_bf16_f32 v129, v122, v123
    v_cvt_pk_bf16_f32 v130, v124, v125
    v_cvt_pk_bf16_f32 v131, v126, v127
    s_mov_b32 s34, 12288
    buffer_store_dwordx4 v[128:131], v1, s[28:31], s34 offen offset:1024 sc1
    v_accvgpr_read_b32 v136, a112
    v_accvgpr_read_b32 v137, a113
    v_accvgpr_read_b32 v138, a114
    v_accvgpr_read_b32 v139, a115
    v_accvgpr_read_b32 v140, a116
    v_accvgpr_read_b32 v141, a117
    v_accvgpr_read_b32 v142, a118
    v_accvgpr_read_b32 v143, a119
    v_cvt_pk_bf16_f32 v144, v136, v137
    v_cvt_pk_bf16_f32 v145, v138, v139
    v_cvt_pk_bf16_f32 v146, v140, v141
    v_cvt_pk_bf16_f32 v147, v142, v143
    s_mov_b32 s34, 12288
    buffer_store_dwordx4 v[144:147], v1, s[28:31], s34 offen offset:2048 sc1
    v_accvgpr_read_b32 v152, a120
    v_accvgpr_read_b32 v153, a121
    v_accvgpr_read_b32 v154, a122
    v_accvgpr_read_b32 v155, a123
    v_accvgpr_read_b32 v156, a124
    v_accvgpr_read_b32 v157, a125
    v_accvgpr_read_b32 v158, a126
    v_accvgpr_read_b32 v159, a127
    v_cvt_pk_bf16_f32 v160, v152, v153
    v_cvt_pk_bf16_f32 v161, v154, v155
    v_cvt_pk_bf16_f32 v162, v156, v157
    v_cvt_pk_bf16_f32 v163, v158, v159
    s_mov_b32 s34, 12288
    buffer_store_dwordx4 v[160:163], v1, s[28:31], s34 offen offset:3072 sc1
    v_accvgpr_read_b32 v104, a128
    v_accvgpr_read_b32 v105, a129
    v_accvgpr_read_b32 v106, a130
    v_accvgpr_read_b32 v107, a131
    v_accvgpr_read_b32 v108, a132
    v_accvgpr_read_b32 v109, a133
    v_accvgpr_read_b32 v110, a134
    v_accvgpr_read_b32 v111, a135
    v_cvt_pk_bf16_f32 v112, v104, v105
    v_cvt_pk_bf16_f32 v113, v106, v107
    v_cvt_pk_bf16_f32 v114, v108, v109
    v_cvt_pk_bf16_f32 v115, v110, v111
    s_mov_b32 s34, 16384
    buffer_store_dwordx4 v[112:115], v1, s[28:31], s34 offen offset:0 sc1
    v_accvgpr_read_b32 v120, a136
    v_accvgpr_read_b32 v121, a137
    v_accvgpr_read_b32 v122, a138
    v_accvgpr_read_b32 v123, a139
    v_accvgpr_read_b32 v124, a140
    v_accvgpr_read_b32 v125, a141
    v_accvgpr_read_b32 v126, a142
    v_accvgpr_read_b32 v127, a143
    v_cvt_pk_bf16_f32 v128, v120, v121
    v_cvt_pk_bf16_f32 v129, v122, v123
    v_cvt_pk_bf16_f32 v130, v124, v125
    v_cvt_pk_bf16_f32 v131, v126, v127
    s_mov_b32 s34, 16384
    buffer_store_dwordx4 v[128:131], v1, s[28:31], s34 offen offset:1024 sc1
    v_accvgpr_read_b32 v136, a144
    v_accvgpr_read_b32 v137, a145
    v_accvgpr_read_b32 v138, a146
    v_accvgpr_read_b32 v139, a147
    v_accvgpr_read_b32 v140, a148
    v_accvgpr_read_b32 v141, a149
    v_accvgpr_read_b32 v142, a150
    v_accvgpr_read_b32 v143, a151
    v_cvt_pk_bf16_f32 v144, v136, v137
    v_cvt_pk_bf16_f32 v145, v138, v139
    v_cvt_pk_bf16_f32 v146, v140, v141
    v_cvt_pk_bf16_f32 v147, v142, v143
    s_mov_b32 s34, 16384
    buffer_store_dwordx4 v[144:147], v1, s[28:31], s34 offen offset:2048 sc1
    v_accvgpr_read_b32 v152, a152
    v_accvgpr_read_b32 v153, a153
    v_accvgpr_read_b32 v154, a154
    v_accvgpr_read_b32 v155, a155
    v_accvgpr_read_b32 v156, a156
    v_accvgpr_read_b32 v157, a157
    v_accvgpr_read_b32 v158, a158
    v_accvgpr_read_b32 v159, a159
    v_cvt_pk_bf16_f32 v160, v152, v153
    v_cvt_pk_bf16_f32 v161, v154, v155
    v_cvt_pk_bf16_f32 v162, v156, v157
    v_cvt_pk_bf16_f32 v163, v158, v159
    s_mov_b32 s34, 16384
    buffer_store_dwordx4 v[160:163], v1, s[28:31], s34 offen offset:3072 sc1
    v_accvgpr_read_b32 v104, a160
    v_accvgpr_read_b32 v105, a161
    v_accvgpr_read_b32 v106, a162
    v_accvgpr_read_b32 v107, a163
    v_accvgpr_read_b32 v108, a164
    v_accvgpr_read_b32 v109, a165
    v_accvgpr_read_b32 v110, a166
    v_accvgpr_read_b32 v111, a167
    v_cvt_pk_bf16_f32 v112, v104, v105
    v_cvt_pk_bf16_f32 v113, v106, v107
    v_cvt_pk_bf16_f32 v114, v108, v109
    v_cvt_pk_bf16_f32 v115, v110, v111
    s_mov_b32 s34, 20480
    buffer_store_dwordx4 v[112:115], v1, s[28:31], s34 offen offset:0 sc1
    v_accvgpr_read_b32 v120, a168
    v_accvgpr_read_b32 v121, a169
    v_accvgpr_read_b32 v122, a170
    v_accvgpr_read_b32 v123, a171
    v_accvgpr_read_b32 v124, a172
    v_accvgpr_read_b32 v125, a173
    v_accvgpr_read_b32 v126, a174
    v_accvgpr_read_b32 v127, a175
    v_cvt_pk_bf16_f32 v128, v120, v121
    v_cvt_pk_bf16_f32 v129, v122, v123
    v_cvt_pk_bf16_f32 v130, v124, v125
    v_cvt_pk_bf16_f32 v131, v126, v127
    s_mov_b32 s34, 20480
    buffer_store_dwordx4 v[128:131], v1, s[28:31], s34 offen offset:1024 sc1
    v_accvgpr_read_b32 v136, a176
    v_accvgpr_read_b32 v137, a177
    v_accvgpr_read_b32 v138, a178
    v_accvgpr_read_b32 v139, a179
    v_accvgpr_read_b32 v140, a180
    v_accvgpr_read_b32 v141, a181
    v_accvgpr_read_b32 v142, a182
    v_accvgpr_read_b32 v143, a183
    v_cvt_pk_bf16_f32 v144, v136, v137
    v_cvt_pk_bf16_f32 v145, v138, v139
    v_cvt_pk_bf16_f32 v146, v140, v141
    v_cvt_pk_bf16_f32 v147, v142, v143
    s_mov_b32 s34, 20480
    buffer_store_dwordx4 v[144:147], v1, s[28:31], s34 offen offset:2048 sc1
    v_accvgpr_read_b32 v152, a184
    v_accvgpr_read_b32 v153, a185
    v_accvgpr_read_b32 v154, a186
    v_accvgpr_read_b32 v155, a187
    v_accvgpr_read_b32 v156, a188
    v_accvgpr_read_b32 v157, a189
    v_accvgpr_read_b32 v158, a190
    v_accvgpr_read_b32 v159, a191
    v_cvt_pk_bf16_f32 v160, v152, v153
    v_cvt_pk_bf16_f32 v161, v154, v155
    v_cvt_pk_bf16_f32 v162, v156, v157
    v_cvt_pk_bf16_f32 v163, v158, v159
    s_mov_b32 s34, 20480
    buffer_store_dwordx4 v[160:163], v1, s[28:31], s34 offen offset:3072 sc1
    v_accvgpr_read_b32 v104, a192
    v_accvgpr_read_b32 v105, a193
    v_accvgpr_read_b32 v106, a194
    v_accvgpr_read_b32 v107, a195
    v_accvgpr_read_b32 v108, a196
    v_accvgpr_read_b32 v109, a197
    v_accvgpr_read_b32 v110, a198
    v_accvgpr_read_b32 v111, a199
    v_cvt_pk_bf16_f32 v112, v104, v105
    v_cvt_pk_bf16_f32 v113, v106, v107
    v_cvt_pk_bf16_f32 v114, v108, v109
    v_cvt_pk_bf16_f32 v115, v110, v111
    s_mov_b32 s34, 24576
    buffer_store_dwordx4 v[112:115], v1, s[28:31], s34 offen offset:0 sc1
    v_accvgpr_read_b32 v120, a200
    v_accvgpr_read_b32 v121, a201
    v_accvgpr_read_b32 v122, a202
    v_accvgpr_read_b32 v123, a203
    v_accvgpr_read_b32 v124, a204
    v_accvgpr_read_b32 v125, a205
    v_accvgpr_read_b32 v126, a206
    v_accvgpr_read_b32 v127, a207
    v_cvt_pk_bf16_f32 v128, v120, v121
    v_cvt_pk_bf16_f32 v129, v122, v123
    v_cvt_pk_bf16_f32 v130, v124, v125
    v_cvt_pk_bf16_f32 v131, v126, v127
    s_mov_b32 s34, 24576
    buffer_store_dwordx4 v[128:131], v1, s[28:31], s34 offen offset:1024 sc1
    v_accvgpr_read_b32 v136, a208
    v_accvgpr_read_b32 v137, a209
    v_accvgpr_read_b32 v138, a210
    v_accvgpr_read_b32 v139, a211
    v_accvgpr_read_b32 v140, a212
    v_accvgpr_read_b32 v141, a213
    v_accvgpr_read_b32 v142, a214
    v_accvgpr_read_b32 v143, a215
    v_cvt_pk_bf16_f32 v144, v136, v137
    v_cvt_pk_bf16_f32 v145, v138, v139
    v_cvt_pk_bf16_f32 v146, v140, v141
    v_cvt_pk_bf16_f32 v147, v142, v143
    s_mov_b32 s34, 24576
    buffer_store_dwordx4 v[144:147], v1, s[28:31], s34 offen offset:2048 sc1
    v_accvgpr_read_b32 v152, a216
    v_accvgpr_read_b32 v153, a217
    v_accvgpr_read_b32 v154, a218
    v_accvgpr_read_b32 v155, a219
    v_accvgpr_read_b32 v156, a220
    v_accvgpr_read_b32 v157, a221
    v_accvgpr_read_b32 v158, a222
    v_accvgpr_read_b32 v159, a223
    v_cvt_pk_bf16_f32 v160, v152, v153
    v_cvt_pk_bf16_f32 v161, v154, v155
    v_cvt_pk_bf16_f32 v162, v156, v157
    v_cvt_pk_bf16_f32 v163, v158, v159
    s_mov_b32 s34, 24576
    buffer_store_dwordx4 v[160:163], v1, s[28:31], s34 offen offset:3072 sc1
    v_accvgpr_read_b32 v104, a224
    v_accvgpr_read_b32 v105, a225
    v_accvgpr_read_b32 v106, a226
    v_accvgpr_read_b32 v107, a227
    v_accvgpr_read_b32 v108, a228
    v_accvgpr_read_b32 v109, a229
    v_accvgpr_read_b32 v110, a230
    v_accvgpr_read_b32 v111, a231
    v_cvt_pk_bf16_f32 v112, v104, v105
    v_cvt_pk_bf16_f32 v113, v106, v107
    v_cvt_pk_bf16_f32 v114, v108, v109
    v_cvt_pk_bf16_f32 v115, v110, v111
    s_mov_b32 s34, 28672
    buffer_store_dwordx4 v[112:115], v1, s[28:31], s34 offen offset:0 sc1
    s_nop 7
    s_nop 7
    v_accvgpr_read_b32 v120, a232
    v_accvgpr_read_b32 v121, a233
    v_accvgpr_read_b32 v122, a234
    v_accvgpr_read_b32 v123, a235
    v_accvgpr_read_b32 v124, a236
    v_accvgpr_read_b32 v125, a237
    v_accvgpr_read_b32 v126, a238
    v_accvgpr_read_b32 v127, a239
    v_cvt_pk_bf16_f32 v128, v120, v121
    v_cvt_pk_bf16_f32 v129, v122, v123
    v_cvt_pk_bf16_f32 v130, v124, v125
    v_cvt_pk_bf16_f32 v131, v126, v127
    s_mov_b32 s34, 28672
    buffer_store_dwordx4 v[128:131], v1, s[28:31], s34 offen offset:1024 sc1
    v_accvgpr_read_b32 v136, a240
    v_accvgpr_read_b32 v137, a241
    v_accvgpr_read_b32 v138, a242
    v_accvgpr_read_b32 v139, a243
    v_accvgpr_read_b32 v140, a244
    v_accvgpr_read_b32 v141, a245
    v_accvgpr_read_b32 v142, a246
    v_accvgpr_read_b32 v143, a247
    v_cvt_pk_bf16_f32 v144, v136, v137
    v_cvt_pk_bf16_f32 v145, v138, v139
    v_cvt_pk_bf16_f32 v146, v140, v141
    v_cvt_pk_bf16_f32 v147, v142, v143
    s_mov_b32 s34, 28672
    buffer_store_dwordx4 v[144:147], v1, s[28:31], s34 offen offset:2048 sc1
    v_accvgpr_read_b32 v152, a248
    v_accvgpr_read_b32 v153, a249
    v_accvgpr_read_b32 v154, a250
    v_accvgpr_read_b32 v155, a251
    v_cvt_pk_bf16_f32 v160, v152, v153
    v_cvt_pk_bf16_f32 v161, v154, v155
    v_mov_b32 v162, 0
    v_mov_b32 v163, 0
    s_mov_b32 s34, 28672
    buffer_store_dwordx4 v[160:163], v1, s[28:31], s34 offen offset:3072 sc1
    s_endpgm
L_rarea_0:
    s_nop 7
    v_max3_f32 v17, v176, v177, v178
    v_max3_f32 v18, v179, v180, v181
    v_max3_f32 v17, v17, v182, v183
    v_max_f32 v17, v17, v18
    v_mov_b32 v18, v17
    s_nop 1
    v_permlane32_swap_b32 v17, v18
    s_nop 1
    v_max_f32 v17, v17, v18
    v_mov_b32 v18, v17
    s_nop 1
    v_permlane16_swap_b32 v17, v18
    s_nop 1
    v_max_f32 v17, v17, v18
    s_cmp_eq_u32 s35, 0
    s_cbranch_scc1 L_rarea_0_first
    v_max_f32 v17, 0, v17
    v_sub_f32 v18, 0, v17
    v_exp_f32 v18, v18
    s_nop 0
    v_accvgpr_read_b32 v19, a0
    v_mul_f32 v19, v19, v18
    v_accvgpr_write_b32 a0, v19
    v_accvgpr_read_b32 v19, a1
    v_mul_f32 v19, v19, v18
    v_accvgpr_write_b32 a1, v19
    v_accvgpr_read_b32 v19, a2
    v_mul_f32 v19, v19, v18
    v_accvgpr_write_b32 a2, v19
    v_accvgpr_read_b32 v19, a3
    v_mul_f32 v19, v19, v18
    v_accvgpr_write_b32 a3, v19
    v_accvgpr_read_b32 v19, a28
    v_mul_f32 v19, v19, v18
    v_accvgpr_write_b32 a28, v19
    v_accvgpr_read_b32 v19, a29
    v_mul_f32 v19, v19, v18
    v_accvgpr_write_b32 a29, v19
    v_accvgpr_read_b32 v19, a30
    v_mul_f32 v19, v19, v18
    v_accvgpr_write_b32 a30, v19
    v_accvgpr_read_b32 v19, a31
    v_mul_f32 v19, v19, v18
    v_accvgpr_write_b32 a31, v19
    v_accvgpr_read_b32 v19, a56
    v_mul_f32 v19, v19, v18
    v_accvgpr_write_b32 a56, v19
    v_accvgpr_read_b32 v19, a57
    v_mul_f32 v19, v19, v18
    v_accvgpr_write_b32 a57, v19
    v_accvgpr_read_b32 v19, a58
    v_mul_f32 v19, v19, v18
    v_accvgpr_write_b32 a58, v19
    v_accvgpr_read_b32 v19, a59
    v_mul_f32 v19, v19, v18
    v_accvgpr_write_b32 a59, v19
    v_accvgpr_read_b32 v19, a84
    v_mul_f32 v19, v19, v18
    v_accvgpr_write_b32 a84, v19
    v_accvgpr_read_b32 v19, a85
    v_mul_f32 v19, v19, v18
    v_accvgpr_write_b32 a85, v19
    v_accvgpr_read_b32 v19, a86
    v_mul_f32 v19, v19, v18
    v_accvgpr_write_b32 a86, v19
    v_accvgpr_read_b32 v19, a87
    v_mul_f32 v19, v19, v18
    v_accvgpr_write_b32 a87, v19
    v_accvgpr_read_b32 v19, a112
    v_mul_f32 v19, v19, v18
    v_accvgpr_write_b32 a112, v19
    v_accvgpr_read_b32 v19, a113
    v_mul_f32 v19, v19, v18
    v_accvgpr_write_b32 a113, v19
    v_accvgpr_read_b32 v19, a114
    v_mul_f32 v19, v19, v18
    v_accvgpr_write_b32 a114, v19
    v_accvgpr_read_b32 v19, a115
    v_mul_f32 v19, v19, v18
    v_accvgpr_write_b32 a115, v19
    v_accvgpr_read_b32 v19, a140
    v_mul_f32 v19, v19, v18
    v_accvgpr_write_b32 a140, v19
    v_accvgpr_read_b32 v19, a141
    v_mul_f32 v19, v19, v18
    v_accvgpr_write_b32 a141, v19
    v_accvgpr_read_b32 v19, a142
    v_mul_f32 v19, v19, v18
    v_accvgpr_write_b32 a142, v19
    v_accvgpr_read_b32 v19, a143
    v_mul_f32 v19, v19, v18
    v_accvgpr_write_b32 a143, v19
    v_accvgpr_read_b32 v19, a168
    v_mul_f32 v19, v19, v18
    v_accvgpr_write_b32 a168, v19
    v_accvgpr_read_b32 v19, a169
    v_mul_f32 v19, v19, v18
    v_accvgpr_write_b32 a169, v19
    v_accvgpr_read_b32 v19, a170
    v_mul_f32 v19, v19, v18
    v_accvgpr_write_b32 a170, v19
    v_accvgpr_read_b32 v19, a171
    v_mul_f32 v19, v19, v18
    v_accvgpr_write_b32 a171, v19
    v_accvgpr_read_b32 v19, a196
    v_mul_f32 v19, v19, v18
    v_accvgpr_write_b32 a196, v19
    v_accvgpr_read_b32 v19, a197
    v_mul_f32 v19, v19, v18
    v_accvgpr_write_b32 a197, v19
    v_accvgpr_read_b32 v19, a198
    v_mul_f32 v19, v19, v18
    v_accvgpr_write_b32 a198, v19
    v_accvgpr_read_b32 v19, a199
    v_mul_f32 v19, v19, v18
    v_accvgpr_write_b32 a199, v19
    v_mul_f32 v24, v24, v18
L_rarea_0_first:
    v_sub_f32 v176, v176, v17
    v_sub_f32 v177, v177, v17
    v_sub_f32 v178, v178, v17
    v_sub_f32 v179, v179, v17
    v_sub_f32 v180, v180, v17
    v_sub_f32 v181, v181, v17
    v_sub_f32 v182, v182, v17
    v_sub_f32 v183, v183, v17
    v_sub_f32 v212, v212, v17
    v_sub_f32 v213, v213, v17
    v_sub_f32 v214, v214, v17
    v_sub_f32 v215, v215, v17
    v_exp_f32 v17, v176
    v_exp_f32 v18, v177
    v_exp_f32 v19, v178
    v_exp_f32 v20, v179
    v_add_f32 v23, v17, v18
    v_cvt_pk_bf16_f32 v200, v17, v18
    v_exp_f32 v17, v180
    v_exp_f32 v18, v181
    v_add_f32 v23, v23, v19
    v_add_f32 v23, v23, v20
    v_cvt_pk_bf16_f32 v201, v19, v20
    v_exp_f32 v19, v182
    v_exp_f32 v20, v183
    v_add_f32 v23, v23, v17
    v_add_f32 v23, v23, v18
    v_cvt_pk_bf16_f32 v202, v17, v18
    s_nop 0
    v_add_f32 v23, v23, v19
    v_add_f32 v23, v23, v20
    v_cvt_pk_bf16_f32 v203, v19, v20
    s_nop 1
    s_branch L_rarea_0_ret
L_rarea_1:
    s_nop 7
    v_max3_f32 v17, v184, v185, v186
    v_max3_f32 v18, v187, v188, v189
    v_max3_f32 v17, v17, v190, v191
    v_max_f32 v17, v17, v18
    v_mov_b32 v18, v17
    s_nop 1
    v_permlane32_swap_b32 v17, v18
    s_nop 1
    v_max_f32 v17, v17, v18
    v_mov_b32 v18, v17
    s_nop 1
    v_permlane16_swap_b32 v17, v18
    s_nop 1
    v_max_f32 v17, v17, v18
    s_cmp_eq_u32 s35, 0
    s_cbranch_scc1 L_rarea_1_first
    v_max_f32 v17, 0, v17
    v_sub_f32 v18, 0, v17
    v_exp_f32 v18, v18
    s_nop 0
    v_accvgpr_read_b32 v19, a4
    v_mul_f32 v19, v19, v18
    v_accvgpr_write_b32 a4, v19
    v_accvgpr_read_b32 v19, a5
    v_mul_f32 v19, v19, v18
    v_accvgpr_write_b32 a5, v19
    v_accvgpr_read_b32 v19, a6
    v_mul_f32 v19, v19, v18
    v_accvgpr_write_b32 a6, v19
    v_accvgpr_read_b32 v19, a7
    v_mul_f32 v19, v19, v18
    v_accvgpr_write_b32 a7, v19
    v_accvgpr_read_b32 v19, a32
    v_mul_f32 v19, v19, v18
    v_accvgpr_write_b32 a32, v19
    v_accvgpr_read_b32 v19, a33
    v_mul_f32 v19, v19, v18
    v_accvgpr_write_b32 a33, v19
    v_accvgpr_read_b32 v19, a34
    v_mul_f32 v19, v19, v18
    v_accvgpr_write_b32 a34, v19
    v_accvgpr_read_b32 v19, a35
    v_mul_f32 v19, v19, v18
    v_accvgpr_write_b32 a35, v19
    v_accvgpr_read_b32 v19, a60
    v_mul_f32 v19, v19, v18
    v_accvgpr_write_b32 a60, v19
    v_accvgpr_read_b32 v19, a61
    v_mul_f32 v19, v19, v18
    v_accvgpr_write_b32 a61, v19
    v_accvgpr_read_b32 v19, a62
    v_mul_f32 v19, v19, v18
    v_accvgpr_write_b32 a62, v19
    v_accvgpr_read_b32 v19, a63
    v_mul_f32 v19, v19, v18
    v_accvgpr_write_b32 a63, v19
    v_accvgpr_read_b32 v19, a88
    v_mul_f32 v19, v19, v18
    v_accvgpr_write_b32 a88, v19
    v_accvgpr_read_b32 v19, a89
    v_mul_f32 v19, v19, v18
    v_accvgpr_write_b32 a89, v19
    v_accvgpr_read_b32 v19, a90
    v_mul_f32 v19, v19, v18
    v_accvgpr_write_b32 a90, v19
    v_accvgpr_read_b32 v19, a91
    v_mul_f32 v19, v19, v18
    v_accvgpr_write_b32 a91, v19
    v_accvgpr_read_b32 v19, a116
    v_mul_f32 v19, v19, v18
    v_accvgpr_write_b32 a116, v19
    v_accvgpr_read_b32 v19, a117
    v_mul_f32 v19, v19, v18
    v_accvgpr_write_b32 a117, v19
    v_accvgpr_read_b32 v19, a118
    v_mul_f32 v19, v19, v18
    v_accvgpr_write_b32 a118, v19
    v_accvgpr_read_b32 v19, a119
    v_mul_f32 v19, v19, v18
    v_accvgpr_write_b32 a119, v19
    v_accvgpr_read_b32 v19, a144
    v_mul_f32 v19, v19, v18
    v_accvgpr_write_b32 a144, v19
    v_accvgpr_read_b32 v19, a145
    v_mul_f32 v19, v19, v18
    v_accvgpr_write_b32 a145, v19
    v_accvgpr_read_b32 v19, a146
    v_mul_f32 v19, v19, v18
    v_accvgpr_write_b32 a146, v19
    v_accvgpr_read_b32 v19, a147
    v_mul_f32 v19, v19, v18
    v_accvgpr_write_b32 a147, v19
    v_accvgpr_read_b32 v19, a172
    v_mul_f32 v19, v19, v18
    v_accvgpr_write_b32 a172, v19
    v_accvgpr_read_b32 v19, a173
    v_mul_f32 v19, v19, v18
    v_accvgpr_write_b32 a173, v19
    v_accvgpr_read_b32 v19, a174
    v_mul_f32 v19, v19, v18
    v_accvgpr_write_b32 a174, v19
    v_accvgpr_read_b32 v19, a175
    v_mul_f32 v19, v19, v18
    v_accvgpr_write_b32 a175, v19
    v_accvgpr_read_b32 v19, a200
    v_mul_f32 v19, v19, v18
    v_accvgpr_write_b32 a200, v19
    v_accvgpr_read_b32 v19, a201
    v_mul_f32 v19, v19, v18
    v_accvgpr_write_b32 a201, v19
    v_accvgpr_read_b32 v19, a202
    v_mul_f32 v19, v19, v18
    v_accvgpr_write_b32 a202, v19
    v_accvgpr_read_b32 v19, a203
    v_mul_f32 v19, v19, v18
    v_accvgpr_write_b32 a203, v19
    v_mul_f32 v25, v25, v18
L_rarea_1_first:
    v_sub_f32 v184, v184, v17
    v_sub_f32 v185, v185, v17
    v_sub_f32 v186, v186, v17
    v_sub_f32 v187, v187, v17
    v_sub_f32 v188, v188, v17
    v_sub_f32 v189, v189, v17
    v_sub_f32 v190, v190, v17
    v_sub_f32 v191, v191, v17
    v_sub_f32 v216, v216, v17
    v_sub_f32 v217, v217, v17
    v_sub_f32 v218, v218, v17
    v_sub_f32 v219, v219, v17
    v_exp_f32 v17, v184
    v_exp_f32 v18, v185
    v_exp_f32 v19, v186
    v_exp_f32 v20, v187
    v_add_f32 v23, v17, v18
    v_cvt_pk_bf16_f32 v204, v17, v18
    v_exp_f32 v17, v188
    v_exp_f32 v18, v189
    v_add_f32 v23, v23, v19
    v_add_f32 v23, v23, v20
    v_cvt_pk_bf16_f32 v205, v19, v20
    v_exp_f32 v19, v190
    v_exp_f32 v20, v191
    v_add_f32 v23, v23, v17
    v_add_f32 v23, v23, v18
    v_cvt_pk_bf16_f32 v206, v17, v18
    s_nop 0
    v_add_f32 v23, v23, v19
    v_add_f32 v23, v23, v20
    v_cvt_pk_bf16_f32 v207, v19, v20
    s_nop 1
    s_branch L_rarea_1_ret
L_rarea_2:
    s_nop 7
    v_max3_f32 v17, v192, v193, v194
    v_max3_f32 v18, v195, v196, v197
    v_max3_f32 v17, v17, v198, v199
    v_max_f32 v17, v17, v18
    v_mov_b32 v18, v17
    s_nop 1
    v_permlane32_swap_b32 v17, v18
    s_nop 1
    v_max_f32 v17, v17, v18
    v_mov_b32 v18, v17
    s_nop 1
    v_permlane16_swap_b32 v17, v18
    s_nop 1
    v_max_f32 v17, v17, v18
    s_cmp_eq_u32 s35, 0
    s_cbranch_scc1 L_rarea_2_first
    v_max_f32 v17, 0, v17
    v_sub_f32 v18, 0, v17
    v_exp_f32 v18, v18
    s_nop 0
    v_accvgpr_read_b32 v19, a8
    v_mul_f32 v19, v19, v18
    v_accvgpr_write_b32 a8, v19
    v_accvgpr_read_b32 v19, a9
    v_mul_f32 v19, v19, v18
    v_accvgpr_write_b32 a9, v19
    v_accvgpr_read_b32 v19, a10
    v_mul_f32 v19, v19, v18
    v_accvgpr_write_b32 a10, v19
    v_accvgpr_read_b32 v19, a11
    v_mul_f32 v19, v19, v18
    v_accvgpr_write_b32 a11, v19
    v_accvgpr_read_b32 v19, a36
    v_mul_f32 v19, v19, v18
    v_accvgpr_write_b32 a36, v19
    v_accvgpr_read_b32 v19, a37
    v_mul_f32 v19, v19, v18
    v_accvgpr_write_b32 a37, v19
    v_accvgpr_read_b32 v19, a38
    v_mul_f32 v19, v19, v18
    v_accvgpr_write_b32 a38, v19
    v_accvgpr_read_b32 v19, a39
    v_mul_f32 v19, v19, v18
    v_accvgpr_write_b32 a39, v19
    v_accvgpr_read_b32 v19, a64
    v_mul_f32 v19, v19, v18
    v_accvgpr_write_b32 a64, v19
    v_accvgpr_read_b32 v19, a65
    v_mul_f32 v19, v19, v18
    v_accvgpr_write_b32 a65, v19
    v_accvgpr_read_b32 v19, a66
    v_mul_f32 v19, v19, v18
    v_accvgpr_write_b32 a66, v19
    v_accvgpr_read_b32 v19, a67
    v_mul_f32 v19, v19, v18
    v_accvgpr_write_b32 a67, v19
    v_accvgpr_read_b32 v19, a92
    v_mul_f32 v19, v19, v18
    v_accvgpr_write_b32 a92, v19
    v_accvgpr_read_b32 v19, a93
    v_mul_f32 v19, v19, v18
    v_accvgpr_write_b32 a93, v19
    v_accvgpr_read_b32 v19, a94
    v_mul_f32 v19, v19, v18
    v_accvgpr_write_b32 a94, v19
    v_accvgpr_read_b32 v19, a95
    v_mul_f32 v19, v19, v18
    v_accvgpr_write_b32 a95, v19
    v_accvgpr_read_b32 v19, a120
    v_mul_f32 v19, v19, v18
    v_accvgpr_write_b32 a120, v19
    v_accvgpr_read_b32 v19, a121
    v_mul_f32 v19, v19, v18
    v_accvgpr_write_b32 a121, v19
    v_accvgpr_read_b32 v19, a122
    v_mul_f32 v19, v19, v18
    v_accvgpr_write_b32 a122, v19
    v_accvgpr_read_b32 v19, a123
    v_mul_f32 v19, v19, v18
    v_accvgpr_write_b32 a123, v19
    v_accvgpr_read_b32 v19, a148
    v_mul_f32 v19, v19, v18
    v_accvgpr_write_b32 a148, v19
    v_accvgpr_read_b32 v19, a149
    v_mul_f32 v19, v19, v18
    v_accvgpr_write_b32 a149, v19
    v_accvgpr_read_b32 v19, a150
    v_mul_f32 v19, v19, v18
    v_accvgpr_write_b32 a150, v19
    v_accvgpr_read_b32 v19, a151
    v_mul_f32 v19, v19, v18
    v_accvgpr_write_b32 a151, v19
    v_accvgpr_read_b32 v19, a176
    v_mul_f32 v19, v19, v18
    v_accvgpr_write_b32 a176, v19
    v_accvgpr_read_b32 v19, a177
    v_mul_f32 v19, v19, v18
    v_accvgpr_write_b32 a177, v19
    v_accvgpr_read_b32 v19, a178
    v_mul_f32 v19, v19, v18
    v_accvgpr_write_b32 a178, v19
    v_accvgpr_read_b32 v19, a179
    v_mul_f32 v19, v19, v18
    v_accvgpr_write_b32 a179, v19
    v_accvgpr_read_b32 v19, a204
    v_mul_f32 v19, v19, v18
    v_accvgpr_write_b32 a204, v19
    v_accvgpr_read_b32 v19, a205
    v_mul_f32 v19, v19, v18
    v_accvgpr_write_b32 a205, v19
    v_accvgpr_read_b32 v19, a206
    v_mul_f32 v19, v19, v18
    v_accvgpr_write_b32 a206, v19
    v_accvgpr_read_b32 v19, a207
    v_mul_f32 v19, v19, v18
    v_accvgpr_write_b32 a207, v19
    v_mul_f32 v26, v26, v18
L_rarea_2_first:
    v_sub_f32 v192, v192, v17
    v_sub_f32 v193, v193, v17
    v_sub_f32 v194, v194, v17
    v_sub_f32 v195, v195, v17
    v_sub_f32 v196, v196, v17
    v_sub_f32 v197, v197, v17
    v_sub_f32 v198, v198, v17
    v_sub_f32 v199, v199, v17
    v_sub_f32 v220, v220, v17
    v_sub_f32 v221, v221, v17
    v_sub_f32 v222, v222, v17
    v_sub_f32 v223, v223, v17
    v_exp_f32 v17, v192
    v_exp_f32 v18, v193
    v_exp_f32 v19, v194
    v_exp_f32 v20, v195
    v_add_f32 v23, v17, v18
    v_cvt_pk_bf16_f32 v208, v17, v18
    v_exp_f32 v17, v196
    v_exp_f32 v18, v197
    v_add_f32 v23, v23, v19
    v_add_f32 v23, v23, v20
    v_cvt_pk_bf16_f32 v209, v19, v20
    v_exp_f32 v19, v198
    v_exp_f32 v20, v199
    v_add_f32 v23, v23, v17
    v_add_f32 v23, v23, v18
    v_cvt_pk_bf16_f32 v210, v17, v18
    s_nop 0
    v_add_f32 v23, v23, v19
    v_add_f32 v23, v23, v20
    v_cvt_pk_bf16_f32 v211, v19, v20
    s_nop 1
    s_branch L_rarea_2_ret
L_rarea_3:
    s_nop 7
    v_max3_f32 v17, v184, v185, v186
    v_max3_f32 v18, v187, v188, v189
    v_max3_f32 v17, v17, v190, v191
    v_max_f32 v17, v17, v18
    v_mov_b32 v18, v17
    s_nop 1
    v_permlane32_swap_b32 v17, v18
    s_nop 1
    v_max_f32 v17, v17, v18
    v_mov_b32 v18, v17
    s_nop 1
    v_permlane16_swap_b32 v17, v18
    s_nop 1
    v_max_f32 v17, v17, v18
    s_cmp_eq_u32 s35, 0
    s_cbranch_scc1 L_rarea_3_first
    v_max_f32 v17, 0, v17
    v_sub_f32 v18, 0, v17
    v_exp_f32 v18, v18
    s_nop 0
    v_accvgpr_read_b32 v19, a12
    v_mul_f32 v19, v19, v18
    v_accvgpr_write_b32 a12, v19
    v_accvgpr_read_b32 v19, a13
    v_mul_f32 v19, v19, v18
    v_accvgpr_write_b32 a13, v19
    v_accvgpr_read_b32 v19, a14
    v_mul_f32 v19, v19, v18
    v_accvgpr_write_b32 a14, v19
    v_accvgpr_read_b32 v19, a15
    v_mul_f32 v19, v19, v18
    v_accvgpr_write_b32 a15, v19
    v_accvgpr_read_b32 v19, a40
    v_mul_f32 v19, v19, v18
    v_accvgpr_write_b32 a40, v19
    v_accvgpr_read_b32 v19, a41
    v_mul_f32 v19, v19, v18
    v_accvgpr_write_b32 a41, v19
    v_accvgpr_read_b32 v19, a42
    v_mul_f32 v19, v19, v18
    v_accvgpr_write_b32 a42, v19
    v_accvgpr_read_b32 v19, a43
    v_mul_f32 v19, v19, v18
    v_accvgpr_write_b32 a43, v19
    v_accvgpr_read_b32 v19, a68
    v_mul_f32 v19, v19, v18
    v_accvgpr_write_b32 a68, v19
    v_accvgpr_read_b32 v19, a69
    v_mul_f32 v19, v19, v18
    v_accvgpr_write_b32 a69, v19
    v_accvgpr_read_b32 v19, a70
    v_mul_f32 v19, v19, v18
    v_accvgpr_write_b32 a70, v19
    v_accvgpr_read_b32 v19, a71
    v_mul_f32 v19, v19, v18
    v_accvgpr_write_b32 a71, v19
    v_accvgpr_read_b32 v19, a96
    v_mul_f32 v19, v19, v18
    v_accvgpr_write_b32 a96, v19
    v_accvgpr_read_b32 v19, a97
    v_mul_f32 v19, v19, v18
    v_accvgpr_write_b32 a97, v19
    v_accvgpr_read_b32 v19, a98
    v_mul_f32 v19, v19, v18
    v_accvgpr_write_b32 a98, v19
    v_accvgpr_read_b32 v19, a99
    v_mul_f32 v19, v19, v18
    v_accvgpr_write_b32 a99, v19
    v_accvgpr_read_b32 v19, a124
    v_mul_f32 v19, v19, v18
    v_accvgpr_write_b32 a124, v19
    v_accvgpr_read_b32 v19, a125
    v_mul_f32 v19, v19, v18
    v_accvgpr_write_b32 a125, v19
    v_accvgpr_read_b32 v19, a126
    v_mul_f32 v19, v19, v18
    v_accvgpr_write_b32 a126, v19
    v_accvgpr_read_b32 v19, a127
    v_mul_f32 v19, v19, v18
    v_accvgpr_write_b32 a127, v19
    v_accvgpr_read_b32 v19, a152
    v_mul_f32 v19, v19, v18
    v_accvgpr_write_b32 a152, v19
    v_accvgpr_read_b32 v19, a153
    v_mul_f32 v19, v19, v18
    v_accvgpr_write_b32 a153, v19
    v_accvgpr_read_b32 v19, a154
    v_mul_f32 v19, v19, v18
    v_accvgpr_write_b32 a154, v19
    v_accvgpr_read_b32 v19, a155
    v_mul_f32 v19, v19, v18
    v_accvgpr_write_b32 a155, v19
    v_accvgpr_read_b32 v19, a180
    v_mul_f32 v19, v19, v18
    v_accvgpr_write_b32 a180, v19
    v_accvgpr_read_b32 v19, a181
    v_mul_f32 v19, v19, v18
    v_accvgpr_write_b32 a181, v19
    v_accvgpr_read_b32 v19, a182
    v_mul_f32 v19, v19, v18
    v_accvgpr_write_b32 a182, v19
    v_accvgpr_read_b32 v19, a183
    v_mul_f32 v19, v19, v18
    v_accvgpr_write_b32 a183, v19
    v_accvgpr_read_b32 v19, a208
    v_mul_f32 v19, v19, v18
    v_accvgpr_write_b32 a208, v19
    v_accvgpr_read_b32 v19, a209
    v_mul_f32 v19, v19, v18
    v_accvgpr_write_b32 a209, v19
    v_accvgpr_read_b32 v19, a210
    v_mul_f32 v19, v19, v18
    v_accvgpr_write_b32 a210, v19
    v_accvgpr_read_b32 v19, a211
    v_mul_f32 v19, v19, v18
    v_accvgpr_write_b32 a211, v19
    v_mul_f32 v27, v27, v18
L_rarea_3_first:
    v_sub_f32 v184, v184, v17
    v_sub_f32 v185, v185, v17
    v_sub_f32 v186, v186, v17
    v_sub_f32 v187, v187, v17
    v_sub_f32 v188, v188, v17
    v_sub_f32 v189, v189, v17
    v_sub_f32 v190, v190, v17
    v_sub_f32 v191, v191, v17
    v_sub_f32 v224, v224, v17
    v_sub_f32 v225, v225, v17
    v_sub_f32 v226, v226, v17
    v_sub_f32 v227, v227, v17
    v_exp_f32 v17, v184
    v_exp_f32 v18, v185
    v_exp_f32 v19, v186
    v_exp_f32 v20, v187
    v_add_f32 v23, v17, v18
    v_cvt_pk_bf16_f32 v204, v17, v18
    v_exp_f32 v17, v188
    v_exp_f32 v18, v189
    v_add_f32 v23, v23, v19
    v_add_f32 v23, v23, v20
    v_cvt_pk_bf16_f32 v205, v19, v20
    v_exp_f32 v19, v190
    v_exp_f32 v20, v191
    v_add_f32 v23, v23, v17
    v_add_f32 v23, v23, v18
    v_cvt_pk_bf16_f32 v206, v17, v18
    s_nop 0
    v_add_f32 v23, v23, v19
    v_add_f32 v23, v23, v20
    v_cvt_pk_bf16_f32 v207, v19, v20
    s_nop 1
    s_branch L_rarea_3_ret
L_rarea_4:
    s_nop 7
    v_max3_f32 v17, v192, v193, v194
    v_max3_f32 v18, v195, v196, v197
    v_max3_f32 v17, v17, v198, v199
    v_max_f32 v17, v17, v18
    v_mov_b32 v18, v17
    s_nop 1
    v_permlane32_swap_b32 v17, v18
    s_nop 1
    v_max_f32 v17, v17, v18
    v_mov_b32 v18, v17
    s_nop 1
    v_permlane16_swap_b32 v17, v18
    s_nop 1
    v_max_f32 v17, v17, v18
    s_cmp_eq_u32 s35, 0
    s_cbranch_scc1 L_rarea_4_first
    v_max_f32 v17, 0, v17
    v_sub_f32 v18, 0, v17
    v_exp_f32 v18, v18
    s_nop 0
    v_accvgpr_read_b32 v19, a16
    v_mul_f32 v19, v19, v18
    v_accvgpr_write_b32 a16, v19
    v_accvgpr_read_b32 v19, a17
    v_mul_f32 v19, v19, v18
    v_accvgpr_write_b32 a17, v19
    v_accvgpr_read_b32 v19, a18
    v_mul_f32 v19, v19, v18
    v_accvgpr_write_b32 a18, v19
    v_accvgpr_read_b32 v19, a19
    v_mul_f32 v19, v19, v18
    v_accvgpr_write_b32 a19, v19
    v_accvgpr_read_b32 v19, a44
    v_mul_f32 v19, v19, v18
    v_accvgpr_write_b32 a44, v19
    v_accvgpr_read_b32 v19, a45
    v_mul_f32 v19, v19, v18
    v_accvgpr_write_b32 a45, v19
    v_accvgpr_read_b32 v19, a46
    v_mul_f32 v19, v19, v18
    v_accvgpr_write_b32 a46, v19
    v_accvgpr_read_b32 v19, a47
    v_mul_f32 v19, v19, v18
    v_accvgpr_write_b32 a47, v19
    v_accvgpr_read_b32 v19, a72
    v_mul_f32 v19, v19, v18
    v_accvgpr_write_b32 a72, v19
    v_accvgpr_read_b32 v19, a73
    v_mul_f32 v19, v19, v18
    v_accvgpr_write_b32 a73, v19
    v_accvgpr_read_b32 v19, a74
    v_mul_f32 v19, v19, v18
    v_accvgpr_write_b32 a74, v19
    v_accvgpr_read_b32 v19, a75
    v_mul_f32 v19, v19, v18
    v_accvgpr_write_b32 a75, v19
    v_accvgpr_read_b32 v19, a100
    v_mul_f32 v19, v19, v18
    v_accvgpr_write_b32 a100, v19
    v_accvgpr_read_b32 v19, a101
    v_mul_f32 v19, v19, v18
    v_accvgpr_write_b32 a101, v19
    v_accvgpr_read_b32 v19, a102
    v_mul_f32 v19, v19, v18
    v_accvgpr_write_b32 a102, v19
    v_accvgpr_read_b32 v19, a103
    v_mul_f32 v19, v19, v18
    v_accvgpr_write_b32 a103, v19
    v_accvgpr_read_b32 v19, a128
    v_mul_f32 v19, v19, v18
    v_accvgpr_write_b32 a128, v19
    v_accvgpr_read_b32 v19, a129
    v_mul_f32 v19, v19, v18
    v_accvgpr_write_b32 a129, v19
    v_accvgpr_read_b32 v19, a130
    v_mul_f32 v19, v19, v18
    v_accvgpr_write_b32 a130, v19
    v_accvgpr_read_b32 v19, a131
    v_mul_f32 v19, v19, v18
    v_accvgpr_write_b32 a131, v19
    v_accvgpr_read_b32 v19, a156
    v_mul_f32 v19, v19, v18
    v_accvgpr_write_b32 a156, v19
    v_accvgpr_read_b32 v19, a157
    v_mul_f32 v19, v19, v18
    v_accvgpr_write_b32 a157, v19
    v_accvgpr_read_b32 v19, a158
    v_mul_f32 v19, v19, v18
    v_accvgpr_write_b32 a158, v19
    v_accvgpr_read_b32 v19, a159
    v_mul_f32 v19, v19, v18
    v_accvgpr_write_b32 a159, v19
    v_accvgpr_read_b32 v19, a184
    v_mul_f32 v19, v19, v18
    v_accvgpr_write_b32 a184, v19
    v_accvgpr_read_b32 v19, a185
    v_mul_f32 v19, v19, v18
    v_accvgpr_write_b32 a185, v19
    v_accvgpr_read_b32 v19, a186
    v_mul_f32 v19, v19, v18
    v_accvgpr_write_b32 a186, v19
    v_accvgpr_read_b32 v19, a187
    v_mul_f32 v19, v19, v18
    v_accvgpr_write_b32 a187, v19
    v_accvgpr_read_b32 v19, a212
    v_mul_f32 v19, v19, v18
    v_accvgpr_write_b32 a212, v19
    v_accvgpr_read_b32 v19, a213
    v_mul_f32 v19, v19, v18
    v_accvgpr_write_b32 a213, v19
    v_accvgpr_read_b32 v19, a214
    v_mul_f32 v19, v19, v18
    v_accvgpr_write_b32 a214, v19
    v_accvgpr_read_b32 v19, a215
    v_mul_f32 v19, v19, v18
    v_accvgpr_write_b32 a215, v19
    v_mul_f32 v28, v28, v18
L_rarea_4_first:
    v_sub_f32 v192, v192, v17
    v_sub_f32 v193, v193, v17
    v_sub_f32 v194, v194, v17
    v_sub_f32 v195, v195, v17
    v_sub_f32 v196, v196, v17
    v_sub_f32 v197, v197, v17
    v_sub_f32 v198, v198, v17
    v_sub_f32 v199, v199, v17
    v_sub_f32 v228, v228, v17
    v_sub_f32 v229, v229, v17
    v_sub_f32 v230, v230, v17
    v_sub_f32 v231, v231, v17
    v_exp_f32 v17, v192
    v_exp_f32 v18, v193
    v_exp_f32 v19, v194
    v_exp_f32 v20, v195
    v_add_f32 v23, v17, v18
    v_cvt_pk_bf16_f32 v208, v17, v18
    v_exp_f32 v17, v196
    v_exp_f32 v18, v197
    v_add_f32 v23, v23, v19
    v_add_f32 v23, v23, v20
    v_cvt_pk_bf16_f32 v209, v19, v20
    v_exp_f32 v19, v198
    v_exp_f32 v20, v199
    v_add_f32 v23, v23, v17
    v_add_f32 v23, v23, v18
    v_cvt_pk_bf16_f32 v210, v17, v18
    s_nop 0
    v_add_f32 v23, v23, v19
    v_add_f32 v23, v23, v20
    v_cvt_pk_bf16_f32 v211, v19, v20
    s_nop 1
    s_branch L_rarea_4_ret
L_rarea_5:
    s_nop 7
    v_max3_f32 v17, v184, v185, v186
    v_max3_f32 v18, v187, v188, v189
    v_max3_f32 v17, v17, v190, v191
    v_max_f32 v17, v17, v18
    v_mov_b32 v18, v17
    s_nop 1
    v_permlane32_swap_b32 v17, v18
    s_nop 1
    v_max_f32 v17, v17, v18
    v_mov_b32 v18, v17
    s_nop 1
    v_permlane16_swap_b32 v17, v18
    s_nop 1
    v_max_f32 v17, v17, v18
    s_cmp_eq_u32 s35, 0
    s_cbranch_scc1 L_rarea_5_first
    v_max_f32 v17, 0, v17
    v_sub_f32 v18, 0, v17
    v_exp_f32 v18, v18
    s_nop 0
    v_accvgpr_read_b32 v19, a20
    v_mul_f32 v19, v19, v18
    v_accvgpr_write_b32 a20, v19
    v_accvgpr_read_b32 v19, a21
    v_mul_f32 v19, v19, v18
    v_accvgpr_write_b32 a21, v19
    v_accvgpr_read_b32 v19, a22
    v_mul_f32 v19, v19, v18
    v_accvgpr_write_b32 a22, v19
    v_accvgpr_read_b32 v19, a23
    v_mul_f32 v19, v19, v18
    v_accvgpr_write_b32 a23, v19
    v_accvgpr_read_b32 v19, a48
    v_mul_f32 v19, v19, v18
    v_accvgpr_write_b32 a48, v19
    v_accvgpr_read_b32 v19, a49
    v_mul_f32 v19, v19, v18
    v_accvgpr_write_b32 a49, v19
    v_accvgpr_read_b32 v19, a50
    v_mul_f32 v19, v19, v18
    v_accvgpr_write_b32 a50, v19
    v_accvgpr_read_b32 v19, a51
    v_mul_f32 v19, v19, v18
    v_accvgpr_write_b32 a51, v19
    v_accvgpr_read_b32 v19, a76
    v_mul_f32 v19, v19, v18
    v_accvgpr_write_b32 a76, v19
    v_accvgpr_read_b32 v19, a77
    v_mul_f32 v19, v19, v18
    v_accvgpr_write_b32 a77, v19
    v_accvgpr_read_b32 v19, a78
    v_mul_f32 v19, v19, v18
    v_accvgpr_write_b32 a78, v19
    v_accvgpr_read_b32 v19, a79
    v_mul_f32 v19, v19, v18
    v_accvgpr_write_b32 a79, v19
    v_accvgpr_read_b32 v19, a104
    v_mul_f32 v19, v19, v18
    v_accvgpr_write_b32 a104, v19
    v_accvgpr_read_b32 v19, a105
    v_mul_f32 v19, v19, v18
    v_accvgpr_write_b32 a105, v19
    v_accvgpr_read_b32 v19, a106
    v_mul_f32 v19, v19, v18
    v_accvgpr_write_b32 a106, v19
    v_accvgpr_read_b32 v19, a107
    v_mul_f32 v19, v19, v18
    v_accvgpr_write_b32 a107, v19
    v_accvgpr_read_b32 v19, a132
    v_mul_f32 v19, v19, v18
    v_accvgpr_write_b32 a132, v19
    v_accvgpr_read_b32 v19, a133
    v_mul_f32 v19, v19, v18
    v_accvgpr_write_b32 a133, v19
    v_accvgpr_read_b32 v19, a134
    v_mul_f32 v19, v19, v18
    v_accvgpr_write_b32 a134, v19
    v_accvgpr_read_b32 v19, a135
    v_mul_f32 v19, v19, v18
    v_accvgpr_write_b32 a135, v19
    v_accvgpr_read_b32 v19, a160
    v_mul_f32 v19, v19, v18
    v_accvgpr_write_b32 a160, v19
    v_accvgpr_read_b32 v19, a161
    v_mul_f32 v19, v19, v18
    v_accvgpr_write_b32 a161, v19
    v_accvgpr_read_b32 v19, a162
    v_mul_f32 v19, v19, v18
    v_accvgpr_write_b32 a162, v19
    v_accvgpr_read_b32 v19, a163
    v_mul_f32 v19, v19, v18
    v_accvgpr_write_b32 a163, v19
    v_accvgpr_read_b32 v19, a188
    v_mul_f32 v19, v19, v18
    v_accvgpr_write_b32 a188, v19
    v_accvgpr_read_b32 v19, a189
    v_mul_f32 v19, v19, v18
    v_accvgpr_write_b32 a189, v19
    v_accvgpr_read_b32 v19, a190
    v_mul_f32 v19, v19, v18
    v_accvgpr_write_b32 a190, v19
    v_accvgpr_read_b32 v19, a191
    v_mul_f32 v19, v19, v18
    v_accvgpr_write_b32 a191, v19
    v_accvgpr_read_b32 v19, a216
    v_mul_f32 v19, v19, v18
    v_accvgpr_write_b32 a216, v19
    v_accvgpr_read_b32 v19, a217
    v_mul_f32 v19, v19, v18
    v_accvgpr_write_b32 a217, v19
    v_accvgpr_read_b32 v19, a218
    v_mul_f32 v19, v19, v18
    v_accvgpr_write_b32 a218, v19
    v_accvgpr_read_b32 v19, a219
    v_mul_f32 v19, v19, v18
    v_accvgpr_write_b32 a219, v19
    v_mul_f32 v29, v29, v18
L_rarea_5_first:
    v_sub_f32 v184, v184, v17
    v_sub_f32 v185, v185, v17
    v_sub_f32 v186, v186, v17
    v_sub_f32 v187, v187, v17
    v_sub_f32 v188, v188, v17
    v_sub_f32 v189, v189, v17
    v_sub_f32 v190, v190, v17
    v_sub_f32 v191, v191, v17
    v_sub_f32 v232, v232, v17
    v_sub_f32 v233, v233, v17
    v_sub_f32 v234, v234, v17
    v_sub_f32 v235, v235, v17
    v_exp_f32 v17, v184
    v_exp_f32 v18, v185
    v_exp_f32 v19, v186
    v_exp_f32 v20, v187
    v_add_f32 v23, v17, v18
    v_cvt_pk_bf16_f32 v204, v17, v18
    v_exp_f32 v17, v188
    v_exp_f32 v18, v189
    v_add_f32 v23, v23, v19
    v_add_f32 v23, v23, v20
    v_cvt_pk_bf16_f32 v205, v19, v20
    v_exp_f32 v19, v190
    v_exp_f32 v20, v191
    v_add_f32 v23, v23, v17
    v_add_f32 v23, v23, v18
    v_cvt_pk_bf16_f32 v206, v17, v18
    s_nop 0
    v_add_f32 v23, v23, v19
    v_add_f32 v23, v23, v20
    v_cvt_pk_bf16_f32 v207, v19, v20
    s_nop 1
    s_branch L_rarea_5_ret
L_rarea_6:
    s_nop 7
    v_max3_f32 v17, v192, v193, v194
    v_max3_f32 v18, v195, v196, v197
    v_max3_f32 v17, v17, v198, v199
    v_max_f32 v17, v17, v18
    v_mov_b32 v18, v17
    s_nop 1
    v_permlane32_swap_b32 v17, v18
    s_nop 1
    v_max_f32 v17, v17, v18
    v_mov_b32 v18, v17
    s_nop 1
    v_permlane16_swap_b32 v17, v18
    s_nop 1
    v_max_f32 v17, v17, v18
    s_cmp_eq_u32 s35, 0
    s_cbranch_scc1 L_rarea_6_first
    v_max_f32 v17, 0, v17
    v_sub_f32 v18, 0, v17
    v_exp_f32 v18, v18
    s_nop 0
    v_accvgpr_read_b32 v19, a24
    v_mul_f32 v19, v19, v18
    v_accvgpr_write_b32 a24, v19
    v_accvgpr_read_b32 v19, a25
    v_mul_f32 v19, v19, v18
    v_accvgpr_write_b32 a25, v19
    v_accvgpr_read_b32 v19, a26
    v_mul_f32 v19, v19, v18
    v_accvgpr_write_b32 a26, v19
    v_accvgpr_read_b32 v19, a27
    v_mul_f32 v19, v19, v18
    v_accvgpr_write_b32 a27, v19
    v_accvgpr_read_b32 v19, a52
    v_mul_f32 v19, v19, v18
    v_accvgpr_write_b32 a52, v19
    v_accvgpr_read_b32 v19, a53
    v_mul_f32 v19, v19, v18
    v_accvgpr_write_b32 a53, v19
    v_accvgpr_read_b32 v19, a54
    v_mul_f32 v19, v19, v18
    v_accvgpr_write_b32 a54, v19
    v_accvgpr_read_b32 v19, a55
    v_mul_f32 v19, v19, v18
    v_accvgpr_write_b32 a55, v19
    v_accvgpr_read_b32 v19, a80
    v_mul_f32 v19, v19, v18
    v_accvgpr_write_b32 a80, v19
    v_accvgpr_read_b32 v19, a81
    v_mul_f32 v19, v19, v18
    v_accvgpr_write_b32 a81, v19
    v_accvgpr_read_b32 v19, a82
    v_mul_f32 v19, v19, v18
    v_accvgpr_write_b32 a82, v19
    v_accvgpr_read_b32 v19, a83
    v_mul_f32 v19, v19, v18
    v_accvgpr_write_b32 a83, v19
    v_accvgpr_read_b32 v19, a108
    v_mul_f32 v19, v19, v18
    v_accvgpr_write_b32 a108, v19
    v_accvgpr_read_b32 v19, a109
    v_mul_f32 v19, v19, v18
    v_accvgpr_write_b32 a109, v19
    v_accvgpr_read_b32 v19, a110
    v_mul_f32 v19, v19, v18
    v_accvgpr_write_b32 a110, v19
    v_accvgpr_read_b32 v19, a111
    v_mul_f32 v19, v19, v18
    v_accvgpr_write_b32 a111, v19
    v_accvgpr_read_b32 v19, a136
    v_mul_f32 v19, v19, v18
    v_accvgpr_write_b32 a136, v19
    v_accvgpr_read_b32 v19, a137
    v_mul_f32 v19, v19, v18
    v_accvgpr_write_b32 a137, v19
    v_accvgpr_read_b32 v19, a138
    v_mul_f32 v19, v19, v18
    v_accvgpr_write_b32 a138, v19
    v_accvgpr_read_b32 v19, a139
    v_mul_f32 v19, v19, v18
    v_accvgpr_write_b32 a139, v19
    v_accvgpr_read_b32 v19, a164
    v_mul_f32 v19, v19, v18
    v_accvgpr_write_b32 a164, v19
    v_accvgpr_read_b32 v19, a165
    v_mul_f32 v19, v19, v18
    v_accvgpr_write_b32 a165, v19
    v_accvgpr_read_b32 v19, a166
    v_mul_f32 v19, v19, v18
    v_accvgpr_write_b32 a166, v19
    v_accvgpr_read_b32 v19, a167
    v_mul_f32 v19, v19, v18
    v_accvgpr_write_b32 a167, v19
    v_accvgpr_read_b32 v19, a192
    v_mul_f32 v19, v19, v18
    v_accvgpr_write_b32 a192, v19
    v_accvgpr_read_b32 v19, a193
    v_mul_f32 v19, v19, v18
    v_accvgpr_write_b32 a193, v19
    v_accvgpr_read_b32 v19, a194
    v_mul_f32 v19, v19, v18
    v_accvgpr_write_b32 a194, v19
    v_accvgpr_read_b32 v19, a195
    v_mul_f32 v19, v19, v18
    v_accvgpr_write_b32 a195, v19
    v_accvgpr_read_b32 v19, a220
    v_mul_f32 v19, v19, v18
    v_accvgpr_write_b32 a220, v19
    v_accvgpr_read_b32 v19, a221
    v_mul_f32 v19, v19, v18
    v_accvgpr_write_b32 a221, v19
    v_accvgpr_read_b32 v19, a222
    v_mul_f32 v19, v19, v18
    v_accvgpr_write_b32 a222, v19
    v_accvgpr_read_b32 v19, a223
    v_mul_f32 v19, v19, v18
    v_accvgpr_write_b32 a223, v19
    v_mul_f32 v30, v30, v18
L_rarea_6_first:
    v_sub_f32 v192, v192, v17
    v_sub_f32 v193, v193, v17
    v_sub_f32 v194, v194, v17
    v_sub_f32 v195, v195, v17
    v_sub_f32 v196, v196, v17
    v_sub_f32 v197, v197, v17
    v_sub_f32 v198, v198, v17
    v_sub_f32 v199, v199, v17
    v_sub_f32 v236, v236, v17
    v_sub_f32 v237, v237, v17
    v_sub_f32 v238, v238, v17
    v_sub_f32 v239, v239, v17
    v_exp_f32 v17, v192
    v_exp_f32 v18, v193
    v_exp_f32 v19, v194
    v_exp_f32 v20, v195
    v_add_f32 v23, v17, v18
    v_cvt_pk_bf16_f32 v208, v17, v18
    v_exp_f32 v17, v196
    v_exp_f32 v18, v197
    v_add_f32 v23, v23, v19
    v_add_f32 v23, v23, v20
    v_cvt_pk_bf16_f32 v209, v19, v20
    v_exp_f32 v19, v198
    v_exp_f32 v20, v199
    v_add_f32 v23, v23, v17
    v_add_f32 v23, v23, v18
    v_cvt_pk_bf16_f32 v210, v17, v18
    s_nop 0
    v_add_f32 v23, v23, v19
    v_add_f32 v23, v23, v20
    v_cvt_pk_bf16_f32 v211, v19, v20
    s_nop 1
    s_branch L_rarea_6_ret
L_exit:
    s_endpgm
L_code_end:
.globl attn_reduce_kernel
.p2align 8
.type attn_reduce_kernel,@function
attn_reduce_kernel:
    s_cmp_ge_u32 s2, 1024
    s_cbranch_scc1 R_exit
    s_load_dwordx2 s[4:5], s[0:1], 96
    s_load_dwordx2 s[6:7], s[0:1], 80
    v_lshrrev_b32 v1, 6, v0
    v_and_b32 v2, 63, v0
    v_readfirstlane_b32 s8, v1
    s_lshl_b32 s9, s2, 2
    s_add_u32 s9, s9, s8
    s_and_b32 s12, s9, 31
    s_lshr_b32 s11, s9, 5
    s_and_b32 s13, s11, 3
    s_lshr_b32 s14, s11, 2
    s_lshl_b32 s15, s14, 20
    s_lshl_b32 s16, s13, 15
    s_add_u32 s15, s15, s16
    s_lshl_b32 s16, s12, 10
    s_add_u32 s15, s15, s16
    s_waitcnt lgkmcnt(0)
    s_mov_b32 s20, s4
    s_and_b32 s21, s5, 0xffff
    s_mov_b32 s22, 33554432
    s_mov_b32 s23, 0x20000
    s_mov_b32 s24, s6
    s_and_b32 s25, s7, 0xffff
    s_mov_b32 s26, 4128768
    s_mov_b32 s27, 0x20000
    v_lshlrev_b32 v5, 4, v2
    buffer_load_dwordx4 v[16:19], v5, s[20:23], s15 offen
    s_add_u32 s15, s15, 131072
    buffer_load_dwordx4 v[20:23], v5, s[20:23], s15 offen
    s_add_u32 s15, s15, 131072
    buffer_load_dwordx4 v[24:27], v5, s[20:23], s15 offen
    s_add_u32 s15, s15, 131072
    buffer_load_dwordx4 v[28:31], v5, s[20:23], s15 offen
    s_add_u32 s15, s15, 131072
    buffer_load_dwordx4 v[32:35], v5, s[20:23], s15 offen
    s_add_u32 s15, s15, 131072
    buffer_load_dwordx4 v[36:39], v5, s[20:23], s15 offen
    s_add_u32 s15, s15, 131072
    buffer_load_dwordx4 v[40:43], v5, s[20:23], s15 offen
    s_add_u32 s15, s15, 131072
    buffer_load_dwordx4 v[44:47], v5, s[20:23], s15 offen
    v_and_b32 v3, 15, v2
    v_lshrrev_b32 v4, 4, v2
    s_and_b32 s18, s14, 15
    s_lshr_b32 s19, s14, 4
    s_mul_i32 s18, s18, 112
    s_movk_i32 s28, 2304
    v_add_u32 v6, s18, v3
    v_mul_lo_u32 v6, v6, s28
    v_lshlrev_b32 v4, 3, v4
    v_add_u32 v6, v6, v4
    s_mul_i32 s19, s19, 1152
    s_mul_i32 s29, s13, 288
    s_add_u32 s19, s19, s29
    s_lshl_b32 s30, s12, 1
    s_mul_i32 s31, s30, 9363
    s_lshr_b32 s31, s31, 16
    s_mul_i32 s32, s31, 7
    s_sub_u32 s32, s30, s32
    s_mul_i32 s32, s32, 36864
    s_lshl_b32 s31, s31, 5
    s_add_u32 s32, s32, s31
    s_add_u32 s33, s32, s19
    s_lshl_b32 s30, s12, 1
    s_add_u32 s30, s30, 1
    s_mul_i32 s31, s30, 9363
    s_lshr_b32 s31, s31, 16
    s_mul_i32 s32, s31, 7
    s_sub_u32 s32, s30, s32
    s_mul_i32 s32, s32, 36864
    s_lshl_b32 s31, s31, 5
    s_add_u32 s32, s32, s31
    s_add_u32 s34, s32, s19
    s_cmp_eq_u32 s12, 31
    s_cselect_b32 s34, 0x7f000000, s34
    s_waitcnt vmcnt(7)
    v_lshlrev_b32 v48, 16, v16
    v_and_b32 v49, 0xffff0000, v16
    v_lshlrev_b32 v50, 16, v17
    v_and_b32 v51, 0xffff0000, v17
    v_lshlrev_b32 v52, 16, v18
    v_and_b32 v53, 0xffff0000, v18
    v_lshlrev_b32 v54, 16, v19
    v_and_b32 v55, 0xffff0000, v19
    s_waitcnt vmcnt(6)
    v_lshlrev_b32 v8, 16, v20
    v_and_b32 v9, 0xffff0000, v20
    v_add_f32 v48, v48, v8
    v_add_f32 v49, v49, v9
    v_lshlrev_b32 v8, 16, v21
    v_and_b32 v9, 0xffff0000, v21
    v_add_f32 v50, v50, v8
    v_add_f32 v51, v51, v9
    v_lshlrev_b32 v8, 16, v22
    v_and_b32 v9, 0xffff0000, v22
    v_add_f32 v52, v52, v8
    v_add_f32 v53, v53, v9
    v_lshlrev_b32 v8, 16, v23
    v_and_b32 v9, 0xffff0000, v23
    v_add_f32 v54, v54, v8
    v_add_f32 v55, v55, v9
    s_waitcnt vmcnt(5)
    v_lshlrev_b32 v8, 16, v24
    v_and_b32 v9, 0xffff0000, v24
    v_add_f32 v48, v48, v8
    v_add_f32 v49, v49, v9
    v_lshlrev_b32 v8, 16, v25
    v_and_b32 v9, 0xffff0000, v25
    v_add_f32 v50, v50, v8
    v_add_f32 v51, v51, v9
    v_lshlrev_b32 v8, 16, v26
    v_and_b32 v9, 0xffff0000, v26
    v_add_f32 v52, v52, v8
    v_add_f32 v53, v53, v9
    v_lshlrev_b32 v8, 16, v27
    v_and_b32 v9, 0xffff0000, v27
    v_add_f32 v54, v54, v8
    v_add_f32 v55, v55, v9
    s_waitcnt vmcnt(4)
    v_lshlrev_b32 v8, 16, v28
    v_and_b32 v9, 0xffff0000, v28
    v_add_f32 v48, v48, v8
    v_add_f32 v49, v49, v9
    v_lshlrev_b32 v8, 16, v29
    v_and_b32 v9, 0xffff0000, v29
    v_add_f32 v50, v50, v8
    v_add_f32 v51, v51, v9
    v_lshlrev_b32 v8, 16, v30
    v_and_b32 v9, 0xffff0000, v30
    v_add_f32 v52, v52, v8
    v_add_f32 v53, v53, v9
    v_lshlrev_b32 v8, 16, v31
    v_and_b32 v9, 0xffff0000, v31
    v_add_f32 v54, v54, v8
    v_add_f32 v55, v55, v9
    s_waitcnt vmcnt(3)
    v_lshlrev_b32 v8, 16, v32
    v_and_b32 v9, 0xffff0000, v32
    v_add_f32 v48, v48, v8
    v_add_f32 v49, v49, v9
    v_lshlrev_b32 v8, 16, v33
    v_and_b32 v9, 0xffff0000, v33
    v_add_f32 v50, v50, v8
    v_add_f32 v51, v51, v9
    v_lshlrev_b32 v8, 16, v34
    v_and_b32 v9, 0xffff0000, v34
    v_add_f32 v52, v52, v8
    v_add_f32 v53, v53, v9
    v_lshlrev_b32 v8, 16, v35
    v_and_b32 v9, 0xffff0000, v35
    v_add_f32 v54, v54, v8
    v_add_f32 v55, v55, v9
    s_waitcnt vmcnt(2)
    v_lshlrev_b32 v8, 16, v36
    v_and_b32 v9, 0xffff0000, v36
    v_add_f32 v48, v48, v8
    v_add_f32 v49, v49, v9
    v_lshlrev_b32 v8, 16, v37
    v_and_b32 v9, 0xffff0000, v37
    v_add_f32 v50, v50, v8
    v_add_f32 v51, v51, v9
    v_lshlrev_b32 v8, 16, v38
    v_and_b32 v9, 0xffff0000, v38
    v_add_f32 v52, v52, v8
    v_add_f32 v53, v53, v9
    v_lshlrev_b32 v8, 16, v39
    v_and_b32 v9, 0xffff0000, v39
    v_add_f32 v54, v54, v8
    v_add_f32 v55, v55, v9
    s_waitcnt vmcnt(1)
    v_lshlrev_b32 v8, 16, v40
    v_and_b32 v9, 0xffff0000, v40
    v_add_f32 v48, v48, v8
    v_add_f32 v49, v49, v9
    v_lshlrev_b32 v8, 16, v41
    v_and_b32 v9, 0xffff0000, v41
    v_add_f32 v50, v50, v8
    v_add_f32 v51, v51, v9
    v_lshlrev_b32 v8, 16, v42
    v_and_b32 v9, 0xffff0000, v42
    v_add_f32 v52, v52, v8
    v_add_f32 v53, v53, v9
    v_lshlrev_b32 v8, 16, v43
    v_and_b32 v9, 0xffff0000, v43
    v_add_f32 v54, v54, v8
    v_add_f32 v55, v55, v9
    s_waitcnt vmcnt(0)
    v_lshlrev_b32 v8, 16, v44
    v_and_b32 v9, 0xffff0000, v44
    v_add_f32 v48, v48, v8
    v_add_f32 v49, v49, v9
    v_lshlrev_b32 v8, 16, v45
    v_and_b32 v9, 0xffff0000, v45
    v_add_f32 v50, v50, v8
    v_add_f32 v51, v51, v9
    v_lshlrev_b32 v8, 16, v46
    v_and_b32 v9, 0xffff0000, v46
    v_add_f32 v52, v52, v8
    v_add_f32 v53, v53, v9
    v_lshlrev_b32 v8, 16, v47
    v_and_b32 v9, 0xffff0000, v47
    v_add_f32 v54, v54, v8
    v_add_f32 v55, v55, v9
    v_cvt_pk_bf16_f32 v56, v48, v49
    v_cvt_pk_bf16_f32 v57, v50, v51
    v_cvt_pk_bf16_f32 v58, v52, v53
    v_cvt_pk_bf16_f32 v59, v54, v55
    buffer_store_dwordx2 v[56:57], v6, s[24:27], s33 offen
    buffer_store_dwordx2 v[58:59], v6, s[24:27], s34 offen
R_exit:
    s_endpgm
.section .rodata,"a"
.p2align 6
.amdhsa_kernel attn_main_kernel
  .amdhsa_next_free_vgpr 512
  .amdhsa_next_free_sgpr 100
  .amdhsa_accum_offset 256
  .amdhsa_group_segment_fixed_size 0
  .amdhsa_kernarg_size 104
  .amdhsa_user_sgpr_count 2
  .amdhsa_user_sgpr_kernarg_segment_ptr 1
  .amdhsa_system_sgpr_workgroup_id_x 1
.end_amdhsa_kernel
.p2align 6
.amdhsa_kernel attn_reduce_kernel
  .amdhsa_next_free_vgpr 64
  .amdhsa_next_free_sgpr 40
  .amdhsa_accum_offset 64
  .amdhsa_group_segment_fixed_size 0
  .amdhsa_kernarg_size 104
  .amdhsa_user_sgpr_count 2
  .amdhsa_user_sgpr_kernarg_segment_ptr 1
  .amdhsa_system_sgpr_workgroup_id_x 1
.end_amdhsa_kernel
```
